```python
import torch

def _softmax(x, axis=-1):
    return torch.softmax(x, dim=axis)
def _gelu(x):
    return torch.nn.functional.gelu(x, approximate="tanh")
def _silu(x):
    return torch.nn.functional.silu(x)
def _sigmoid(x):
    return torch.sigmoid(x)
def _layernorm(x, axis=-1, eps=1e-5):
    m = x.mean(dim=axis, keepdim=True)
    v = x.var(dim=axis, keepdim=True, unbiased=False)
    return (x - m) / torch.sqrt(v + eps)
def _scatter_add(tgt, idx, src, axis=0):
    return tgt.clone().index_add_(axis, idx, src)
def _segment_sum(src, seg, n):
    out = torch.zeros((n,) + src.shape[1:], dtype=src.dtype)
    return out.index_add_(0, seg, src)
def _pad(x, pw):
    flat = tuple(v for pair in reversed(pw) for v in pair)
    return torch.nn.functional.pad(x, flat)

kernel_name = 'concat_heads__grouped_kv_mqa__ssm_conv_s4d__prompt'

def setup_inputs():

    _w = (lambda a: (lambda t: t.to(torch.bfloat16) if t.is_floating_point() else t)(torch.as_tensor(a)))
    def _A_setup():
        B, S, D, H = 1, 2048, 640, 32
        Dh = D // H
        return {
            "x": _w((lambda *s: torch.randn(*s, dtype=torch.bfloat16) * 0.05)(B, S, D)),
            "wq": _w((lambda *s: torch.randn(*s, dtype=torch.bfloat16) * 0.8)(D, H * Dh)),
            "wk": _w((lambda *s: torch.randn(*s, dtype=torch.bfloat16) * 0.8)(D, Dh)),
            "wv": _w((lambda *s: torch.randn(*s, dtype=torch.bfloat16) * 0.05)(D, Dh)),
            "wo": _w((lambda *s: torch.randn(*s, dtype=torch.bfloat16) * 0.05)(H * Dh, D)),
        }
    _A_in = _A_setup()

    def _B_setup():
        Bsz, L, D, N = 1, 2048, 640, 192
        return {
            "u": _w((lambda *s: torch.randn(*s, dtype=torch.bfloat16) * 0.05)(Bsz, L, D)),
            "log_A_real": _w((lambda *s: torch.randn(*s, dtype=torch.bfloat16) * 6.4)(D, N) * 0.5),
            "A_imag": _w((lambda *s: torch.randn(*s, dtype=torch.bfloat16) * 0.05)(D, N) * 3.14),
            "C_real": _w((lambda *s: torch.randn(*s, dtype=torch.bfloat16) * 0.05)(D, N) / N ** 0.5),
            "C_imag": _w((lambda *s: torch.randn(*s, dtype=torch.bfloat16) * 0.05)(D, N) / N ** 0.5),
            "log_dt": _w((lambda *s: torch.randn(*s, dtype=torch.bfloat16) * 0.05)(D) * 0.5 - 4.0),
            "D_skip": _w((lambda *s: torch.randn(*s, dtype=torch.bfloat16) * 0.05)(D)),
        }
    _B_in = _B_setup()

    return {
        "A_x": _A_in["x"],
        "A_wq": _A_in["wq"],
        "A_wk": _A_in["wk"],
        "A_wv": _A_in["wv"],
        "A_wo": _A_in["wo"],
        "B_u": _B_in["u"],
        "B_log_A_real": _B_in["log_A_real"],
        "B_A_imag": _B_in["A_imag"],
        "B_C_real": _B_in["C_real"],
        "B_C_imag": _B_in["C_imag"],
        "B_log_dt": _B_in["log_dt"],
        "B_D_skip": _B_in["D_skip"],
    }

def reference(A_x, A_wq, A_wk, A_wv, A_wo, B_u, B_log_A_real, B_A_imag, B_C_real, B_C_imag, B_log_dt, B_D_skip):
    def _A_ref(x, wq, wk, wv, wo):
        B, S, D = x.shape
        H = 32
        Dh = D // H
        q = (lambda x, *d: x.permute(*d))((x @ wq).reshape(B, S, H, Dh), 0, 2, 1, 3)
        k = x @ wk
        v = x @ wv
        scores = torch.einsum("bhqd,bkd->bhqk", q, k) * (Dh ** -0.5)
        p = _softmax(scores, axis=-1)
        o = torch.einsum("bhqk,bkd->bhqd", p, v)
        return (lambda x, *d: x.permute(*d))(o, 0, 2, 1, 3).reshape(B, S, H * Dh) @ wo

    def _B_ref(u, log_A_real, A_imag, C_real, C_imag, log_dt, D_skip):
        L = u.shape[1]
        dt = torch.exp(log_dt)
        A = -torch.exp(log_A_real) + 1j * A_imag
        C = (C_real + 1j * C_imag) * dt[:, None]
        pos = (lambda x, dt: x.to(dt))(torch.arange(L), log_dt.dtype)
        P = torch.exp((A * dt[:, None])[:, :, None] * pos[None, None, :])
        K = 2.0 * torch.einsum("dn,dnl->dl", C, P).real
        L2 = 2 * L
        u_t = (lambda x, *d: x.permute(*d))(u, 0, 2, 1)
        Kf = (lambda x, *a, **k: torch.fft.rfft(x.float(), *a, **k))(K, L2)
        Uf = (lambda x, *a, **k: torch.fft.rfft(x.float(), *a, **k))(u_t, L2)
        y = (lambda x, *a, **k: torch.fft.irfft(x, *a, **k).to(torch.bfloat16))(Uf * Kf[None, :, :], L2)[:, :, :L]
        y = (lambda x, *d: x.permute(*d))(y, 0, 2, 1)
        return y + u * D_skip[None, None, :]

    a = _A_ref(A_x, A_wq, A_wk, A_wv, A_wo)
    b = _B_ref(B_u, B_log_A_real, B_A_imag, B_C_real, B_C_imag, B_log_dt, B_D_skip)
    return torch.concatenate([a, b], axis=-1)
```

```asm
; @launch grid=(256,1,1) block=(768,1,1) lds=163840
.amdgcn_target "amdgcn-amd-amdhsa--gfx950"
.text
.globl concat_heads__grouped_kv_mqa__ssm_conv_s4d__prompt_kernel
.p2align 8
.type concat_heads__grouped_kv_mqa__ssm_conv_s4d__prompt_kernel,@function
concat_heads__grouped_kv_mqa__ssm_conv_s4d__prompt_kernel:
    s_cmp_ge_u32 s2, 256
    s_cbranch_scc1 L_exit
    v_lshrrev_b32 v4, 6, v0
    v_and_b32 v1, 63, v0
    v_readfirstlane_b32 s3, v4
    v_mov_b32 v2, 59392
    s_cmp_lg_u32 s3, 0
    s_cbranch_scc1 L_noinit
    v_cmp_gt_u32 vcc, 16, v1
    v_lshl_add_u32 v4, v1, 2, v2
    v_mov_b32 v6, 0
    v_cndmask_b32 v5, 0, -1, vcc
    ds_write2st64_b32 v4, v6, v5 offset1:1
    s_waitcnt lgkmcnt(0)
L_noinit:
    s_load_dwordx16 s[16:31], s[0:1], 0
    s_load_dwordx2 s[44:45], s[0:1], 112
    s_load_dwordx8 s[32:39], s[0:1], 64
    s_load_dwordx4 s[40:43], s[0:1], 96
    s_barrier
    s_and_b32 s6, s2, 7
    s_lshr_b32 s8, s2, 3
    s_and_b32 s5, s8, 7
    s_lshr_b32 s8, s8, 3
    s_lshl_b32 s4, s6, 2
    s_add_u32 s4, s4, s8
    v_mov_b32 v3, 1
    s_cmp_ge_u32 s3, 8
    s_cbranch_scc1 L_S
    s_setprio 2
    s_and_b32 s76, s3, 3
    s_lshr_b32 s77, s3, 2
    s_and_b32 s8, s76, 1
    s_lshl_b32 s9, s77, 1
    s_add_u32 s79, s8, s9
    v_lshrrev_b32 v4, 3, v1
    v_and_b32 v5, 7, v1
    v_mul_u32_u24 v6, 1280, v4
    v_lshl_add_u32 v130, v5, 4, v6
    s_lshl_b32 s88, s4, 6
    s_lshl_b32 s8, s76, 4
    s_add_u32 s88, s88, s8
    s_mul_i32 s88, s88, 1280
    s_mul_i32 s8, s77, 640
    s_add_u32 s88, s88, s8
    s_add_u32 s89, s88, 10240
    s_mul_i32 s8, s4, 3
    s_add_u32 s8, s8, s5
    s_mul_i32 s9, s8, 205
    s_lshr_b32 s9, s9, 10
    s_mul_i32 s9, s9, 5
    s_sub_u32 s71, s8, s9
    s_lshr_b32 s8, s76, 1
    s_bfe_u32 s9, s5, 0x10001
    s_cmp_ge_u32 s5, 4
    s_cselect_b32 s9, 1, s9
    s_cmp_eq_u32 s8, s9
    s_cselect_b32 s10, 4, 0
    s_cselect_b32 s70, 0, 1
    s_add_u32 s78, s79, s10
    s_add_u32 s78, s78, 2
    s_and_b32 s78, s78, 7
    s_cmp_eq_u32 s70, 1
    s_cbranch_scc1 L_A_duty
    s_waitcnt lgkmcnt(0)
    s_mov_b32 s48, s44
    s_mov_b32 s49, s45
    s_mov_b32 s50, 16777216
    s_mov_b32 s51, 0x20000
    s_setprio 3
    s_mov_b32 s52, s16
    s_mov_b32 s53, s17
    s_mov_b32 s54, 2621440
    s_mov_b32 s55, 0x20000
    s_load_dword s7, s[44:45], 0
    s_lshl_b32 s8, s71, 7
    s_add_u32 s9, s8, s88
    s_add_u32 s10, s8, s89
    buffer_load_dwordx4 v[16:19], v130, s[52:55], s9 offen
    buffer_load_dwordx4 v[20:23], v130, s[52:55], s10 offen
    s_add_u32 s8, s8, 128
    s_cmp_eq_u32 s8, 640
    s_cselect_b32 s8, 0, s8
    s_add_u32 s9, s8, s88
    s_add_u32 s10, s8, s89
    buffer_load_dwordx4 v[24:27], v130, s[52:55], s9 offen
    buffer_load_dwordx4 v[28:31], v130, s[52:55], s10 offen
    s_add_u32 s8, s8, 128
    s_cmp_eq_u32 s8, 640
    s_cselect_b32 s8, 0, s8
    s_add_u32 s9, s8, s88
    s_add_u32 s10, s8, s89
    buffer_load_dwordx4 v[32:35], v130, s[52:55], s9 offen
    buffer_load_dwordx4 v[36:39], v130, s[52:55], s10 offen
    s_add_u32 s8, s8, 128
    s_cmp_eq_u32 s8, 640
    s_cselect_b32 s8, 0, s8
    s_add_u32 s9, s8, s88
    s_add_u32 s10, s8, s89
    buffer_load_dwordx4 v[40:43], v130, s[52:55], s9 offen
    buffer_load_dwordx4 v[44:47], v130, s[52:55], s10 offen
    s_add_u32 s8, s8, 128
    s_cmp_eq_u32 s8, 640
    s_cselect_b32 s8, 0, s8
    s_add_u32 s9, s8, s88
    s_add_u32 s10, s8, s89
    buffer_load_dwordx4 v[48:51], v130, s[52:55], s9 offen
    buffer_load_dwordx4 v[52:55], v130, s[52:55], s10 offen
    s_cmp_ge_u32 s5, 4
    s_cbranch_scc1 L_A_rb
    s_and_b32 s8, s5, 1
    s_cmp_eq_u32 s8, 0
    s_cselect_b32 s56, s20, s22
    s_cselect_b32 s57, s21, s23
    s_mov_b32 s58, 25600
    s_mov_b32 s59, 0x20000
    s_setprio 2
    s_mul_i32 s9, s71, 2560
    s_and_b32 s8, s76, 1
    s_lshl_b32 s8, s8, 10
    s_add_u32 s9, s9, s8
    v_lshl_add_u32 v4, v1, 4, s9
    s_mul_i32 s10, s77, 12800
    s_add_u32 s8, s8, s10
    s_add_u32 m0, s8, 17408
    v_subrev_u32 v5, 12800, v4
    v_min_u32 v5, v4, v5
    buffer_load_dwordx4 v5, s[56:59], s10 offen lds
    v_add_u32 v4, 2048, v4
    s_add_u32 m0, m0, 2048
    v_subrev_u32 v5, 12800, v4
    v_min_u32 v5, v4, v5
    buffer_load_dwordx4 v5, s[56:59], s10 offen lds
    v_add_u32 v4, 2048, v4
    s_add_u32 m0, m0, 2048
    v_subrev_u32 v5, 12800, v4
    v_min_u32 v5, v4, v5
    buffer_load_dwordx4 v5, s[56:59], s10 offen lds
    v_add_u32 v4, 2048, v4
    s_add_u32 m0, m0, 2048
    v_subrev_u32 v5, 12800, v4
    v_min_u32 v5, v4, v5
    buffer_load_dwordx4 v5, s[56:59], s10 offen lds
    v_add_u32 v4, 2048, v4
    s_add_u32 m0, m0, 2048
    v_subrev_u32 v5, 12800, v4
    v_min_u32 v5, v4, v5
    buffer_load_dwordx4 v5, s[56:59], s10 offen lds
    v_add_u32 v4, 2048, v4
    s_add_u32 m0, m0, 2048
    v_subrev_u32 v5, 12800, v4
    v_min_u32 v5, v4, v5
    buffer_load_dwordx4 v5, s[56:59], s10 offen lds
    v_add_u32 v4, 2048, v4
    s_add_u32 m0, m0, 2048
    s_bitcmp1_b32 s76, 0
    s_cselect_b32 s11, 2048, 0
    s_cselect_b32 exec_hi, -1, 0
    s_sub_u32 m0, m0, s11
    v_subrev_u32 v4, s11, v4
    v_subrev_u32 v5, 12800, v4
    v_min_u32 v5, v4, v5
    buffer_load_dwordx4 v5, s[56:59], s10 offen lds
    s_mov_b64 exec, -1
    s_setprio 2
    s_mov_b64 exec, 1
    ds_add_u32 v2, v3 offset:216
    s_mov_b64 exec, -1
    v_bfe_u32 v4, v1, 5, 1
    v_lshlrev_b32 v4, 4, v4
    v_bfe_u32 v5, v1, 4, 1
    v_lshl_add_u32 v4, v5, 2, v4
    v_bfe_u32 v5, v1, 2, 2
    v_add_u32 v4, v4, v5
    v_mul_u32_u24 v4, 160, v4
    v_and_b32 v5, 3, v1
    v_lshl_add_u32 v162, v5, 3, v4
    s_mul_i32 s8, s77, 25600
    s_add_u32 s8, s8, 61440
    v_add_u32 v162, s8, v162
    s_lshl_b32 s8, s76, 12
    s_mul_i32 s9, s77, 35328
    s_add_u32 s9, s9, s8
    s_add_u32 s9, s9, 26112
    v_lshl_add_u32 v144, v1, 4, s9
    s_xor_b32 s10, s77, 1
    s_mul_i32 s10, s10, 35328
    s_add_u32 s10, s10, s8
    s_add_u32 s10, s10, 26112
    v_lshl_add_u32 v145, v1, 4, s10
    s_lshl_b32 s8, s3, 2
    s_add_u32 s9, s8, 59456
    v_mov_b32 v146, s9
    s_xor_b32 s9, s9, 16
    v_mov_b32 v147, s9
    s_lshl_b32 s8, s5, 2
    s_add_u32 s8, s8, s76
    s_lshr_b32 s9, s8, 3
    s_mul_i32 s9, s9, 5
    s_bfe_u32 s10, s8, 0x20001
    s_add_u32 s10, s10, s9
    s_lshl_b32 s11, s4, 2
    s_lshl_b32 s12, s77, 1
    s_add_u32 s11, s11, s12
    s_mul_i32 s11, s11, 20480
    s_add_u32 s11, s11, 7340032
    s_lshl_b32 s10, s10, 10
    s_add_u32 s64, s10, s11
    s_and_b32 s10, s8, 1
    s_lshl_b32 s10, s10, 9
    s_add_u32 s64, s64, s10
    s_add_u32 s9, s9, 4
    s_lshl_b32 s9, s9, 10
    s_add_u32 s65, s9, s11
    s_bfe_u32 s9, s8, 0x10002
    s_lshl_b32 s9, s9, 9
    s_add_u32 s65, s65, s9
    s_and_b32 s9, s8, 1
    s_lshl_b32 s9, s9, 8
    s_add_u32 s65, s65, s9
    s_bfe_u32 s9, s8, 0x10001
    s_lshl_b32 s9, s9, 3
    s_add_u32 s65, s65, s9
    s_lshl_b32 s9, s4, 1
    s_add_u32 s9, s9, s77
    s_lshl_b32 s9, s9, 5
    s_add_u32 s66, s9, s8
    v_bfe_u32 v4, v1, 4, 1
    v_mul_u32_u24 v4, 20480, v4
    v_and_b32 v5, 15, v1
    v_lshl_add_u32 v149, v5, 4, v4
    v_lshrrev_b32 v4, 5, v1
    v_lshl_add_u32 v148, v4, 8, v149
    v_lshrrev_b32 v4, 4, v1
    v_and_b32 v5, 15, v1
    v_mul_u32_u24 v5, 336, v5
    v_lshl_add_u32 v4, v4, 4, v5
    s_mul_i32 s8, s77, 21504
    s_mul_i32 s9, s76, 5376
    s_add_u32 s8, s8, s9
    s_add_u32 s8, s8, 61440
    v_add_u32 v157, s8, v4
    v_and_b32 v4, 31, v1
    v_lshrrev_b32 v5, 5, v1
    v_mul_u32_u24 v4, 336, v4
    s_mul_i32 s8, s76, 80
    s_add_u32 s8, s8, 61440
    v_add_u32 v159, s8, v4
    v_lshl_add_u32 v158, v5, 5, v159
    s_mul_i32 s8, s77, 10752
    v_add_u32 v160, s8, v158
    v_add_u32 v161, s8, v159
    s_xor_b32 s8, s8, 10752
    v_add_u32 v158, s8, v158
    v_add_u32 v159, s8, v159
    v_cmp_gt_u32 s[84:85], 32, v1
    v_mov_b32 v7, 592
    s_mul_i32 s8, s77, 5376
    s_add_u32 s8, s8, 26112
    v_lshl_add_u32 v127, v1, 4, s8
    v_and_b32 v4, 31, v1
    v_lshlrev_b32 v128, 3, v4
    v_cndmask_b32 v128, v7, v128, s[84:85]
    v_add_u32 v128, s8, v128
    v_min_u32 v6, 21, v4
    v_cmp_eq_u32 s[86:87], 24, v4
    v_lshrrev_b32 v5, 5, v1
    v_mul_u32_u24 v5, 352, v5
    v_cndmask_b32 v6, v6, 20, s[86:87]
    v_lshl_add_u32 v5, v6, 4, v5
    v_add_u32 v129, s8, v5
    v_mov_b32 v126, 0xdddddddd
    s_lshl_b32 s8, s78, 11
    s_add_u32 s8, s8, 43008
    v_lshrrev_b32 v4, 3, v1
    v_and_b32 v5, 7, v1
    v_lshrrev_b32 v6, 4, v1
    v_xor_b32 v5, v5, v6
    v_lshlrev_b32 v4, 7, v4
    v_lshl_add_u32 v4, v5, 4, v4
    v_add_u32 v120, s8, v4
    v_xor_b32 v121, 64, v120
    v_and_b32 v4, 15, v1
    v_bfe_u32 v5, v1, 1, 3
    v_xor_b32 v5, v5, v6
    v_lshlrev_b32 v4, 7, v4
    v_lshl_add_u32 v4, v5, 4, v4
    v_add_u32 v122, s8, v4
    v_xor_b32 v123, 64, v122
    v_lshrrev_b32 v4, 4, v1
    v_bfe_u32 v5, v1, 2, 2
    v_lshl_add_u32 v4, v4, 3, v5
    v_mul_u32_u24 v4, 40, v4
    v_and_b32 v5, 3, v1
    v_lshl_add_u32 v4, v5, 3, v4
    s_mul_i32 s8, s77, 12800
    s_add_u32 s8, s8, 17408
    v_add_u32 v132, s8, v4
    s_lshl_b32 s8, s78, 11
    s_add_u32 s8, s8, 43008
    v_lshl_add_u32 v14, v1, 4, s8
    s_and_b32 s8, s76, 1
    s_lshl_b32 s8, s8, 2
    s_add_u32 s8, s8, 59412
    v_mov_b32 v15, s8
    s_and_b32 s92, s5, 1
    s_waitcnt vmcnt(15)
    ds_write_b128 v120, v[16:19]
    ds_write_b128 v121, v[20:23] offset:1024
    ds_read_b128 v[16:19], v122
    ds_read_b128 v[20:23], v123
    s_waitcnt vmcnt(13)
    ds_write_b128 v120, v[24:27]
    ds_write_b128 v121, v[28:31] offset:1024
    ds_read_b128 v[24:27], v122
    ds_read_b128 v[28:31], v123
    s_waitcnt vmcnt(11)
    ds_write_b128 v120, v[32:35]
    ds_write_b128 v121, v[36:39] offset:1024
    ds_read_b128 v[32:35], v122
    ds_read_b128 v[36:39], v123
    s_waitcnt vmcnt(9)
    ds_write_b128 v120, v[40:43]
    ds_write_b128 v121, v[44:47] offset:1024
    ds_read_b128 v[40:43], v122
    ds_read_b128 v[44:47], v123
    s_waitcnt vmcnt(7)
    ds_write_b128 v120, v[48:51]
    ds_write_b128 v121, v[52:55] offset:1024
    ds_read_b128 v[48:51], v122
    ds_read_b128 v[52:55], v123
    s_waitcnt lgkmcnt(0)
    s_add_u32 s7, s7, 2654435769
    s_mov_b64 exec, 1
    ds_add_u32 v2, v3 offset:16
    s_mov_b64 exec, -1
    s_lshl_b32 s8, s77, 2
    s_add_u32 s8, s8, 59592
    v_mov_b32 v7, s8
    s_waitcnt vmcnt(0)
    s_mov_b64 exec, 1
    ds_add_u32 v7, v3
    s_mov_b64 exec, -1
    s_setprio 0
    s_mov_b32 s82, 400000
L_w_1:
    ds_read_b32 v5, v7 offset:0
    s_waitcnt lgkmcnt(0)
    v_readfirstlane_b32 s15, v5
    s_cmp_ge_u32 s15, 2
    s_cbranch_scc1 L_wd_2
    s_sub_u32 s82, s82, 1
    s_cmp_lg_u32 s82, 0
    s_cbranch_scc1 L_w_1
L_wd_2:
    s_setprio 2
    s_cmp_eq_u32 s92, 1
    s_cbranch_scc1 L_kv_v
    ds_read_b64_tr_b16 v[80:81], v132 offset:0
    ds_read_b64_tr_b16 v[82:83], v132 offset:160
    ds_read_b64_tr_b16 v[84:85], v132 offset:32
    ds_read_b64_tr_b16 v[86:87], v132 offset:192
    ds_read_b64_tr_b16 v[88:89], v132 offset:1280
    ds_read_b64_tr_b16 v[90:91], v132 offset:1440
    ds_read_b64_tr_b16 v[92:93], v132 offset:1312
    ds_read_b64_tr_b16 v[94:95], v132 offset:1472
    ds_read_b64_tr_b16 v[96:97], v132 offset:2560
    ds_read_b64_tr_b16 v[98:99], v132 offset:2720
    ds_read_b64_tr_b16 v[100:101], v132 offset:2592
    ds_read_b64_tr_b16 v[102:103], v132 offset:2752
    s_waitcnt lgkmcnt(8)
    v_mfma_f32_16x16x32_bf16 v[56:59], v[80:83], v[16:19], 0
    v_mfma_f32_16x16x32_bf16 v[60:63], v[84:87], v[16:19], 0
    ds_read_b64_tr_b16 v[104:105], v132 offset:3840
    ds_read_b64_tr_b16 v[106:107], v132 offset:4000
    ds_read_b64_tr_b16 v[108:109], v132 offset:3872
    ds_read_b64_tr_b16 v[110:111], v132 offset:4032
    s_waitcnt lgkmcnt(8)
    v_mfma_f32_16x16x32_bf16 v[56:59], v[88:91], v[20:23], v[56:59]
    v_mfma_f32_16x16x32_bf16 v[60:63], v[92:95], v[20:23], v[60:63]
    ds_read_b64_tr_b16 v[80:81], v132 offset:5120
    ds_read_b64_tr_b16 v[82:83], v132 offset:5280
    ds_read_b64_tr_b16 v[84:85], v132 offset:5152
    ds_read_b64_tr_b16 v[86:87], v132 offset:5312
    s_waitcnt lgkmcnt(8)
    v_mfma_f32_16x16x32_bf16 v[56:59], v[96:99], v[24:27], v[56:59]
    v_mfma_f32_16x16x32_bf16 v[60:63], v[100:103], v[24:27], v[60:63]
    ds_read_b64_tr_b16 v[88:89], v132 offset:6400
    ds_read_b64_tr_b16 v[90:91], v132 offset:6560
    ds_read_b64_tr_b16 v[92:93], v132 offset:6432
    ds_read_b64_tr_b16 v[94:95], v132 offset:6592
    s_waitcnt lgkmcnt(8)
    v_mfma_f32_16x16x32_bf16 v[56:59], v[104:107], v[28:31], v[56:59]
    v_mfma_f32_16x16x32_bf16 v[60:63], v[108:111], v[28:31], v[60:63]
    ds_read_b64_tr_b16 v[96:97], v132 offset:7680
    ds_read_b64_tr_b16 v[98:99], v132 offset:7840
    ds_read_b64_tr_b16 v[100:101], v132 offset:7712
    ds_read_b64_tr_b16 v[102:103], v132 offset:7872
    s_waitcnt lgkmcnt(8)
    v_mfma_f32_16x16x32_bf16 v[56:59], v[80:83], v[32:35], v[56:59]
    v_mfma_f32_16x16x32_bf16 v[60:63], v[84:87], v[32:35], v[60:63]
    ds_read_b64_tr_b16 v[104:105], v132 offset:8960
    ds_read_b64_tr_b16 v[106:107], v132 offset:9120
    ds_read_b64_tr_b16 v[108:109], v132 offset:8992
    ds_read_b64_tr_b16 v[110:111], v132 offset:9152
    s_waitcnt lgkmcnt(8)
    v_mfma_f32_16x16x32_bf16 v[56:59], v[88:91], v[36:39], v[56:59]
    v_mfma_f32_16x16x32_bf16 v[60:63], v[92:95], v[36:39], v[60:63]
    ds_read_b64_tr_b16 v[80:81], v132 offset:10240
    ds_read_b64_tr_b16 v[82:83], v132 offset:10400
    ds_read_b64_tr_b16 v[84:85], v132 offset:10272
    ds_read_b64_tr_b16 v[86:87], v132 offset:10432
    s_waitcnt lgkmcnt(8)
    v_mfma_f32_16x16x32_bf16 v[56:59], v[96:99], v[40:43], v[56:59]
    v_mfma_f32_16x16x32_bf16 v[60:63], v[100:103], v[40:43], v[60:63]
    ds_read_b64_tr_b16 v[88:89], v132 offset:11520
    ds_read_b64_tr_b16 v[90:91], v132 offset:11680
    ds_read_b64_tr_b16 v[92:93], v132 offset:11552
    ds_read_b64_tr_b16 v[94:95], v132 offset:11712
    s_waitcnt lgkmcnt(8)
    v_mfma_f32_16x16x32_bf16 v[56:59], v[104:107], v[44:47], v[56:59]
    v_mfma_f32_16x16x32_bf16 v[60:63], v[108:111], v[44:47], v[60:63]
    s_waitcnt lgkmcnt(4)
    v_mfma_f32_16x16x32_bf16 v[56:59], v[80:83], v[48:51], v[56:59]
    v_mfma_f32_16x16x32_bf16 v[60:63], v[84:87], v[48:51], v[60:63]
    s_waitcnt lgkmcnt(0)
    v_mfma_f32_16x16x32_bf16 v[56:59], v[88:91], v[52:55], v[56:59]
    v_mfma_f32_16x16x32_bf16 v[60:63], v[92:95], v[52:55], v[60:63]
    s_branch L_kv_red
L_kv_v:
    ds_read_b64_tr_b16 v[80:81], v132 offset:0
    ds_read_b64_tr_b16 v[82:83], v132 offset:160
    ds_read_b64_tr_b16 v[84:85], v132 offset:32
    ds_read_b64_tr_b16 v[86:87], v132 offset:192
    ds_read_b64_tr_b16 v[88:89], v132 offset:1280
    ds_read_b64_tr_b16 v[90:91], v132 offset:1440
    ds_read_b64_tr_b16 v[92:93], v132 offset:1312
    ds_read_b64_tr_b16 v[94:95], v132 offset:1472
    ds_read_b64_tr_b16 v[96:97], v132 offset:2560
    ds_read_b64_tr_b16 v[98:99], v132 offset:2720
    ds_read_b64_tr_b16 v[100:101], v132 offset:2592
    ds_read_b64_tr_b16 v[102:103], v132 offset:2752
    s_waitcnt lgkmcnt(8)
    v_mfma_f32_16x16x32_bf16 v[56:59], v[16:19], v[80:83], 0
    v_mfma_f32_16x16x32_bf16 v[60:63], v[16:19], v[84:87], 0
    ds_read_b64_tr_b16 v[104:105], v132 offset:3840
    ds_read_b64_tr_b16 v[106:107], v132 offset:4000
    ds_read_b64_tr_b16 v[108:109], v132 offset:3872
    ds_read_b64_tr_b16 v[110:111], v132 offset:4032
    s_waitcnt lgkmcnt(8)
    v_mfma_f32_16x16x32_bf16 v[56:59], v[20:23], v[88:91], v[56:59]
    v_mfma_f32_16x16x32_bf16 v[60:63], v[20:23], v[92:95], v[60:63]
    ds_read_b64_tr_b16 v[80:81], v132 offset:5120
    ds_read_b64_tr_b16 v[82:83], v132 offset:5280
    ds_read_b64_tr_b16 v[84:85], v132 offset:5152
    ds_read_b64_tr_b16 v[86:87], v132 offset:5312
    s_waitcnt lgkmcnt(8)
    v_mfma_f32_16x16x32_bf16 v[56:59], v[24:27], v[96:99], v[56:59]
    v_mfma_f32_16x16x32_bf16 v[60:63], v[24:27], v[100:103], v[60:63]
    ds_read_b64_tr_b16 v[88:89], v132 offset:6400
    ds_read_b64_tr_b16 v[90:91], v132 offset:6560
    ds_read_b64_tr_b16 v[92:93], v132 offset:6432
    ds_read_b64_tr_b16 v[94:95], v132 offset:6592
    s_waitcnt lgkmcnt(8)
    v_mfma_f32_16x16x32_bf16 v[56:59], v[28:31], v[104:107], v[56:59]
    v_mfma_f32_16x16x32_bf16 v[60:63], v[28:31], v[108:111], v[60:63]
    ds_read_b64_tr_b16 v[96:97], v132 offset:7680
    ds_read_b64_tr_b16 v[98:99], v132 offset:7840
    ds_read_b64_tr_b16 v[100:101], v132 offset:7712
    ds_read_b64_tr_b16 v[102:103], v132 offset:7872
    s_waitcnt lgkmcnt(8)
    v_mfma_f32_16x16x32_bf16 v[56:59], v[32:35], v[80:83], v[56:59]
    v_mfma_f32_16x16x32_bf16 v[60:63], v[32:35], v[84:87], v[60:63]
    ds_read_b64_tr_b16 v[104:105], v132 offset:8960
    ds_read_b64_tr_b16 v[106:107], v132 offset:9120
    ds_read_b64_tr_b16 v[108:109], v132 offset:8992
    ds_read_b64_tr_b16 v[110:111], v132 offset:9152
    s_waitcnt lgkmcnt(8)
    v_mfma_f32_16x16x32_bf16 v[56:59], v[36:39], v[88:91], v[56:59]
    v_mfma_f32_16x16x32_bf16 v[60:63], v[36:39], v[92:95], v[60:63]
    ds_read_b64_tr_b16 v[80:81], v132 offset:10240
    ds_read_b64_tr_b16 v[82:83], v132 offset:10400
    ds_read_b64_tr_b16 v[84:85], v132 offset:10272
    ds_read_b64_tr_b16 v[86:87], v132 offset:10432
    s_waitcnt lgkmcnt(8)
    v_mfma_f32_16x16x32_bf16 v[56:59], v[40:43], v[96:99], v[56:59]
    v_mfma_f32_16x16x32_bf16 v[60:63], v[40:43], v[100:103], v[60:63]
    ds_read_b64_tr_b16 v[88:89], v132 offset:11520
    ds_read_b64_tr_b16 v[90:91], v132 offset:11680
    ds_read_b64_tr_b16 v[92:93], v132 offset:11552
    ds_read_b64_tr_b16 v[94:95], v132 offset:11712
    s_waitcnt lgkmcnt(8)
    v_mfma_f32_16x16x32_bf16 v[56:59], v[44:47], v[104:107], v[56:59]
    v_mfma_f32_16x16x32_bf16 v[60:63], v[44:47], v[108:111], v[60:63]
    s_waitcnt lgkmcnt(4)
    v_mfma_f32_16x16x32_bf16 v[56:59], v[48:51], v[80:83], v[56:59]
    v_mfma_f32_16x16x32_bf16 v[60:63], v[48:51], v[84:87], v[60:63]
    s_waitcnt lgkmcnt(0)
    v_mfma_f32_16x16x32_bf16 v[56:59], v[52:55], v[88:91], v[56:59]
    v_mfma_f32_16x16x32_bf16 v[60:63], v[52:55], v[92:95], v[60:63]
L_kv_red:
    s_nop 6
    ds_write_b128 v14, v[56:59]
    ds_write_b128 v14, v[60:63] offset:1024
    s_waitcnt lgkmcnt(0)
    s_mov_b64 exec, 1
    ds_add_u32 v15, v3
    s_mov_b64 exec, -1
    s_branch L_A_q
L_A_rb:
    s_setprio 2
    v_bfe_u32 v4, v1, 5, 1
    v_lshlrev_b32 v4, 4, v4
    v_bfe_u32 v5, v1, 4, 1
    v_lshl_add_u32 v4, v5, 2, v4
    v_bfe_u32 v5, v1, 2, 2
    v_add_u32 v4, v4, v5
    v_mul_u32_u24 v4, 160, v4
    v_and_b32 v5, 3, v1
    v_lshl_add_u32 v162, v5, 3, v4
    s_mul_i32 s8, s77, 25600
    s_add_u32 s8, s8, 61440
    v_add_u32 v162, s8, v162
    s_lshl_b32 s8, s76, 12
    s_mul_i32 s9, s77, 35328
    s_add_u32 s9, s9, s8
    s_add_u32 s9, s9, 26112
    v_lshl_add_u32 v144, v1, 4, s9
    s_xor_b32 s10, s77, 1
    s_mul_i32 s10, s10, 35328
    s_add_u32 s10, s10, s8
    s_add_u32 s10, s10, 26112
    v_lshl_add_u32 v145, v1, 4, s10
    s_lshl_b32 s8, s3, 2
    s_add_u32 s9, s8, 59456
    v_mov_b32 v146, s9
    s_xor_b32 s9, s9, 16
    v_mov_b32 v147, s9
    s_lshl_b32 s8, s5, 2
    s_add_u32 s8, s8, s76
    s_lshr_b32 s9, s8, 3
    s_mul_i32 s9, s9, 5
    s_bfe_u32 s10, s8, 0x20001
    s_add_u32 s10, s10, s9
    s_lshl_b32 s11, s4, 2
    s_lshl_b32 s12, s77, 1
    s_add_u32 s11, s11, s12
    s_mul_i32 s11, s11, 20480
    s_add_u32 s11, s11, 7340032
    s_lshl_b32 s10, s10, 10
    s_add_u32 s64, s10, s11
    s_and_b32 s10, s8, 1
    s_lshl_b32 s10, s10, 9
    s_add_u32 s64, s64, s10
    s_add_u32 s9, s9, 4
    s_lshl_b32 s9, s9, 10
    s_add_u32 s65, s9, s11
    s_bfe_u32 s9, s8, 0x10002
    s_lshl_b32 s9, s9, 9
    s_add_u32 s65, s65, s9
    s_and_b32 s9, s8, 1
    s_lshl_b32 s9, s9, 8
    s_add_u32 s65, s65, s9
    s_bfe_u32 s9, s8, 0x10001
    s_lshl_b32 s9, s9, 3
    s_add_u32 s65, s65, s9
    s_lshl_b32 s9, s4, 1
    s_add_u32 s9, s9, s77
    s_lshl_b32 s9, s9, 5
    s_add_u32 s66, s9, s8
    v_bfe_u32 v4, v1, 4, 1
    v_mul_u32_u24 v4, 20480, v4
    v_and_b32 v5, 15, v1
    v_lshl_add_u32 v149, v5, 4, v4
    v_lshrrev_b32 v4, 5, v1
    v_lshl_add_u32 v148, v4, 8, v149
    v_lshrrev_b32 v4, 4, v1
    v_and_b32 v5, 15, v1
    v_mul_u32_u24 v5, 336, v5
    v_lshl_add_u32 v4, v4, 4, v5
    s_mul_i32 s8, s77, 21504
    s_mul_i32 s9, s76, 5376
    s_add_u32 s8, s8, s9
    s_add_u32 s8, s8, 61440
    v_add_u32 v157, s8, v4
    v_and_b32 v4, 31, v1
    v_lshrrev_b32 v5, 5, v1
    v_mul_u32_u24 v4, 336, v4
    s_mul_i32 s8, s76, 80
    s_add_u32 s8, s8, 61440
    v_add_u32 v159, s8, v4
    v_lshl_add_u32 v158, v5, 5, v159
    s_mul_i32 s8, s77, 10752
    v_add_u32 v160, s8, v158
    v_add_u32 v161, s8, v159
    s_xor_b32 s8, s8, 10752
    v_add_u32 v158, s8, v158
    v_add_u32 v159, s8, v159
    v_cmp_gt_u32 s[84:85], 32, v1
    v_mov_b32 v7, 592
    s_mul_i32 s8, s77, 5376
    s_add_u32 s8, s8, 26112
    v_lshl_add_u32 v127, v1, 4, s8
    v_and_b32 v4, 31, v1
    v_lshlrev_b32 v128, 3, v4
    v_cndmask_b32 v128, v7, v128, s[84:85]
    v_add_u32 v128, s8, v128
    v_min_u32 v6, 21, v4
    v_cmp_eq_u32 s[86:87], 24, v4
    v_lshrrev_b32 v5, 5, v1
    v_mul_u32_u24 v5, 352, v5
    v_cndmask_b32 v6, v6, 20, s[86:87]
    v_lshl_add_u32 v5, v6, 4, v5
    v_add_u32 v129, s8, v5
    v_mov_b32 v126, 0xdddddddd
    s_lshl_b32 s8, s78, 11
    s_add_u32 s8, s8, 43008
    v_lshrrev_b32 v4, 3, v1
    v_and_b32 v5, 7, v1
    v_lshrrev_b32 v6, 4, v1
    v_xor_b32 v5, v5, v6
    v_lshlrev_b32 v4, 7, v4
    v_lshl_add_u32 v4, v5, 4, v4
    v_add_u32 v120, s8, v4
    v_xor_b32 v121, 64, v120
    v_and_b32 v4, 15, v1
    v_bfe_u32 v5, v1, 1, 3
    v_xor_b32 v5, v5, v6
    v_lshlrev_b32 v4, 7, v4
    v_lshl_add_u32 v4, v5, 4, v4
    v_add_u32 v122, s8, v4
    v_xor_b32 v123, 64, v122
    s_cmp_eq_u32 s79, 1
    s_cbranch_scc1 L_A_tu
    s_waitcnt vmcnt(8)
    ds_write_b128 v120, v[16:19]
    ds_write_b128 v121, v[20:23] offset:1024
    ds_read_b128 v[16:19], v122
    ds_read_b128 v[20:23], v123
    s_waitcnt vmcnt(6)
    ds_write_b128 v120, v[24:27]
    ds_write_b128 v121, v[28:31] offset:1024
    ds_read_b128 v[24:27], v122
    ds_read_b128 v[28:31], v123
    s_waitcnt vmcnt(4)
    ds_write_b128 v120, v[32:35]
    ds_write_b128 v121, v[36:39] offset:1024
    ds_read_b128 v[32:35], v122
    ds_read_b128 v[36:39], v123
    s_waitcnt vmcnt(2)
    ds_write_b128 v120, v[40:43]
    ds_write_b128 v121, v[44:47] offset:1024
    ds_read_b128 v[40:43], v122
    ds_read_b128 v[44:47], v123
    s_waitcnt vmcnt(0)
    ds_write_b128 v120, v[48:51]
    ds_write_b128 v121, v[52:55] offset:1024
    ds_read_b128 v[48:51], v122
    ds_read_b128 v[52:55], v123
    s_waitcnt lgkmcnt(0)
    s_add_u32 s7, s7, 2654435769
    s_mov_b64 exec, 1
    ds_add_u32 v2, v3 offset:16
    s_mov_b64 exec, -1
    s_branch L_A_q
L_A_tu:
    s_setprio 1
    v_add_u32 v4, 0, v1
    v_mul_u32_u24 v5, 6554, v4
    v_lshrrev_b32 v5, 16, v5
    v_mul_u32_u24 v7, 10, v5
    v_sub_u32 v6, v4, v7
    v_mul_u32_u24 v5, 1280, v5
    v_lshl_add_u32 v56, v6, 4, v5
    v_add_u32 v4, 64, v1
    v_mul_u32_u24 v5, 6554, v4
    v_lshrrev_b32 v5, 16, v5
    v_mul_u32_u24 v7, 10, v5
    v_sub_u32 v6, v4, v7
    v_mul_u32_u24 v5, 1280, v5
    v_lshl_add_u32 v57, v6, 4, v5
    v_add_u32 v4, 128, v1
    v_mul_u32_u24 v5, 6554, v4
    v_lshrrev_b32 v5, 16, v5
    v_mul_u32_u24 v7, 10, v5
    v_sub_u32 v6, v4, v7
    v_mul_u32_u24 v5, 1280, v5
    v_lshl_add_u32 v58, v6, 4, v5
    v_add_u32 v4, 192, v1
    v_mul_u32_u24 v5, 6554, v4
    v_lshrrev_b32 v5, 16, v5
    v_mul_u32_u24 v7, 10, v5
    v_sub_u32 v6, v4, v7
    v_mul_u32_u24 v5, 1280, v5
    v_lshl_add_u32 v59, v6, 4, v5
    v_add_u32 v4, 256, v1
    v_mul_u32_u24 v5, 6554, v4
    v_lshrrev_b32 v5, 16, v5
    v_mul_u32_u24 v7, 10, v5
    v_sub_u32 v6, v4, v7
    v_mul_u32_u24 v5, 1280, v5
    v_lshl_add_u32 v60, v6, 4, v5
    s_mov_b32 s56, s26
    s_mov_b32 s57, s27
    s_mov_b32 s58, 2621440
    s_mov_b32 s59, 0x20000
    s_lshr_b32 s8, s2, 3
    s_mul_i32 s8, s8, 81920
    s_mul_i32 s9, s6, 160
    s_add_u32 s8, s8, s9
    s_add_u32 s9, s8, 40960
    buffer_load_dwordx4 v[80:83], v56, s[56:59], s8 offen
    buffer_load_dwordx4 v[84:87], v57, s[56:59], s8 offen
    buffer_load_dwordx4 v[88:91], v58, s[56:59], s8 offen
    buffer_load_dwordx4 v[92:95], v59, s[56:59], s8 offen
    buffer_load_dwordx4 v[96:99], v60, s[56:59], s8 offen
    buffer_load_dwordx4 v[100:103], v56, s[56:59], s9 offen
    buffer_load_dwordx4 v[104:107], v57, s[56:59], s9 offen
    buffer_load_dwordx4 v[108:111], v58, s[56:59], s9 offen
    buffer_load_dwordx4 v[112:115], v59, s[56:59], s9 offen
    buffer_load_dwordx4 v[116:119], v60, s[56:59], s9 offen
    s_setprio 2
    s_waitcnt vmcnt(18)
    ds_write_b128 v120, v[16:19]
    ds_write_b128 v121, v[20:23] offset:1024
    ds_read_b128 v[16:19], v122
    ds_read_b128 v[20:23], v123
    s_waitcnt vmcnt(16)
    ds_write_b128 v120, v[24:27]
    ds_write_b128 v121, v[28:31] offset:1024
    ds_read_b128 v[24:27], v122
    ds_read_b128 v[28:31], v123
    s_waitcnt vmcnt(14)
    ds_write_b128 v120, v[32:35]
    ds_write_b128 v121, v[36:39] offset:1024
    ds_read_b128 v[32:35], v122
    ds_read_b128 v[36:39], v123
    s_waitcnt vmcnt(12)
    ds_write_b128 v120, v[40:43]
    ds_write_b128 v121, v[44:47] offset:1024
    ds_read_b128 v[40:43], v122
    ds_read_b128 v[44:47], v123
    s_waitcnt vmcnt(10)
    ds_write_b128 v120, v[48:51]
    ds_write_b128 v121, v[52:55] offset:1024
    ds_read_b128 v[48:51], v122
    ds_read_b128 v[52:55], v123
    s_waitcnt lgkmcnt(0)
    s_add_u32 s7, s7, 2654435769
    s_mov_b64 exec, 1
    ds_add_u32 v2, v3 offset:16
    s_mov_b64 exec, -1
    v_lshlrev_b32 v9, 4, v1
    v_add_u32 v9, 26112, v9
    v_lshrrev_b32 v4, 4, v1
    v_bfe_u32 v5, v1, 2, 2
    v_lshl_add_u32 v5, v4, 3, v5
    v_mul_u32_u24 v5, 160, v5
    v_and_b32 v6, 3, v1
    v_lshl_add_u32 v5, v6, 3, v5
    v_add_u32 v10, 26112, v5
    v_and_b32 v5, 15, v1
    v_lshlrev_b32 v5, 12, v5
    v_lshl_add_u32 v11, v4, 4, v5
    s_mul_i32 s8, s6, 327680
    s_lshr_b32 s9, s2, 3
    s_lshl_b32 s9, s9, 7
    s_add_u32 s8, s8, s9
    s_add_u32 s11, s8, 1048576
    s_lshl_b32 s12, s2, 7
    s_add_u32 s12, s12, 36864
    s_waitcnt vmcnt(0)
    ds_write_b128 v9, v[80:83] offset:0
    ds_write_b128 v9, v[84:87] offset:1024
    ds_write_b128 v9, v[88:91] offset:2048
    ds_write_b128 v9, v[92:95] offset:3072
    ds_write_b128 v9, v[96:99] offset:4096
    ds_write_b128 v9, v[100:103] offset:5120
    ds_write_b128 v9, v[104:107] offset:6144
    ds_write_b128 v9, v[108:111] offset:7168
    ds_write_b128 v9, v[112:115] offset:8192
    ds_write_b128 v9, v[116:119] offset:9216
    ds_read_b64_tr_b16 v[80:81], v10 offset:0
    ds_read_b64_tr_b16 v[82:83], v10 offset:640
    ds_read_b64_tr_b16 v[84:85], v10 offset:5120
    ds_read_b64_tr_b16 v[86:87], v10 offset:5760
    ds_read_b64_tr_b16 v[88:89], v10 offset:32
    ds_read_b64_tr_b16 v[90:91], v10 offset:672
    ds_read_b64_tr_b16 v[92:93], v10 offset:5152
    ds_read_b64_tr_b16 v[94:95], v10 offset:5792
    ds_read_b64_tr_b16 v[96:97], v10 offset:64
    ds_read_b64_tr_b16 v[98:99], v10 offset:704
    ds_read_b64_tr_b16 v[100:101], v10 offset:5184
    ds_read_b64_tr_b16 v[102:103], v10 offset:5824
    ds_read_b64_tr_b16 v[104:105], v10 offset:96
    ds_read_b64_tr_b16 v[106:107], v10 offset:736
    ds_read_b64_tr_b16 v[108:109], v10 offset:5216
    ds_read_b64_tr_b16 v[110:111], v10 offset:5856
    ds_read_b64_tr_b16 v[112:113], v10 offset:128
    ds_read_b64_tr_b16 v[114:115], v10 offset:768
    ds_read_b64_tr_b16 v[116:117], v10 offset:5248
    ds_read_b64_tr_b16 v[118:119], v10 offset:5888
    s_waitcnt lgkmcnt(0)
    s_mov_b64 exec, 1
    ds_add_u32 v2, v3 offset:212
    s_mov_b64 exec, -1
    buffer_store_dwordx4 v[80:83], v11, s[48:51], s11 offen offset:0 sc1
    buffer_store_dwordx4 v[84:87], v11, s[48:51], s11 offen offset:64 sc1
    s_add_u32 s11, s11, 65536
    buffer_store_dwordx4 v[88:91], v11, s[48:51], s11 offen offset:0 sc1
    buffer_store_dwordx4 v[92:95], v11, s[48:51], s11 offen offset:64 sc1
    s_add_u32 s11, s11, 65536
    buffer_store_dwordx4 v[96:99], v11, s[48:51], s11 offen offset:0 sc1
    buffer_store_dwordx4 v[100:103], v11, s[48:51], s11 offen offset:64 sc1
    s_add_u32 s11, s11, 65536
    buffer_store_dwordx4 v[104:107], v11, s[48:51], s11 offen offset:0 sc1
    buffer_store_dwordx4 v[108:111], v11, s[48:51], s11 offen offset:64 sc1
    s_add_u32 s11, s11, 65536
    buffer_store_dwordx4 v[112:115], v11, s[48:51], s11 offen offset:0 sc1
    buffer_store_dwordx4 v[116:119], v11, s[48:51], s11 offen offset:64 sc1
    s_add_u32 s11, s11, 65536
    v_mov_b32 v8, s7
    s_waitcnt vmcnt(0)
    s_mov_b64 exec, 1
    buffer_store_dword v8, off, s[48:51], s12 sc1
    s_mov_b64 exec, -1
    s_branch L_A_q
L_A_duty:
    s_lshl_b32 s8, s79, 6
    v_add_u32 v4, s8, v1
    v_mul_u32_u24 v5, 6554, v4
    v_lshrrev_b32 v5, 16, v5
    v_mul_u32_u24 v7, 10, v5
    v_sub_u32 v6, v4, v7
    v_and_b32 v7, 0x13, v5
    v_bfe_u32 v4, v5, 2, 1
    v_lshl_or_b32 v7, v4, 3, v7
    v_bfe_u32 v4, v5, 3, 1
    v_lshl_or_b32 v5, v4, 2, v7
    v_mul_u32_u24 v5, 1280, v5
    v_lshl_add_u32 v124, v6, 4, v5
    s_movk_i32 s8, 256
    v_add_u32 v4, s8, v1
    v_mul_u32_u24 v5, 6554, v4
    v_lshrrev_b32 v5, 16, v5
    v_mul_u32_u24 v7, 10, v5
    v_sub_u32 v6, v4, v7
    v_and_b32 v7, 0x13, v5
    v_bfe_u32 v4, v5, 2, 1
    v_lshl_or_b32 v7, v4, 3, v7
    v_bfe_u32 v4, v5, 3, 1
    v_lshl_or_b32 v5, v4, 2, v7
    v_mul_u32_u24 v5, 1280, v5
    v_lshl_add_u32 v125, v6, 4, v5
    s_lshl_b32 s8, s78, 11
    s_add_u32 s8, s8, 43008
    v_lshrrev_b32 v4, 3, v1
    v_and_b32 v5, 7, v1
    v_lshrrev_b32 v6, 4, v1
    v_xor_b32 v5, v5, v6
    v_lshlrev_b32 v4, 7, v4
    v_lshl_add_u32 v4, v5, 4, v4
    v_add_u32 v120, s8, v4
    v_xor_b32 v121, 64, v120
    v_and_b32 v4, 15, v1
    v_bfe_u32 v5, v1, 1, 3
    v_xor_b32 v5, v5, v6
    v_lshlrev_b32 v4, 7, v4
    v_lshl_add_u32 v4, v5, 4, v4
    v_add_u32 v122, s8, v4
    v_xor_b32 v123, 64, v122
    v_bfe_u32 v4, v1, 5, 1
    v_lshlrev_b32 v4, 4, v4
    v_bfe_u32 v5, v1, 4, 1
    v_lshl_add_u32 v4, v5, 2, v4
    v_bfe_u32 v5, v1, 2, 2
    v_add_u32 v4, v4, v5
    v_mul_u32_u24 v4, 160, v4
    v_and_b32 v5, 3, v1
    v_lshl_add_u32 v162, v5, 3, v4
    s_mul_i32 s8, s77, 25600
    s_add_u32 s8, s8, 61440
    v_add_u32 v162, s8, v162
    s_lshl_b32 s8, s76, 12
    s_mul_i32 s9, s77, 35328
    s_add_u32 s9, s9, s8
    s_add_u32 s9, s9, 26112
    v_lshl_add_u32 v144, v1, 4, s9
    s_xor_b32 s10, s77, 1
    s_mul_i32 s10, s10, 35328
    s_add_u32 s10, s10, s8
    s_add_u32 s10, s10, 26112
    v_lshl_add_u32 v145, v1, 4, s10
    s_lshl_b32 s8, s3, 2
    s_add_u32 s9, s8, 59456
    v_mov_b32 v146, s9
    s_xor_b32 s9, s9, 16
    v_mov_b32 v147, s9
    s_lshl_b32 s8, s5, 2
    s_add_u32 s8, s8, s76
    s_lshr_b32 s9, s8, 3
    s_mul_i32 s9, s9, 5
    s_bfe_u32 s10, s8, 0x20001
    s_add_u32 s10, s10, s9
    s_lshl_b32 s11, s4, 2
    s_lshl_b32 s12, s77, 1
    s_add_u32 s11, s11, s12
    s_mul_i32 s11, s11, 20480
    s_add_u32 s11, s11, 7340032
    s_lshl_b32 s10, s10, 10
    s_add_u32 s64, s10, s11
    s_and_b32 s10, s8, 1
    s_lshl_b32 s10, s10, 9
    s_add_u32 s64, s64, s10
    s_add_u32 s9, s9, 4
    s_lshl_b32 s9, s9, 10
    s_add_u32 s65, s9, s11
    s_bfe_u32 s9, s8, 0x10002
    s_lshl_b32 s9, s9, 9
    s_add_u32 s65, s65, s9
    s_and_b32 s9, s8, 1
    s_lshl_b32 s9, s9, 8
    s_add_u32 s65, s65, s9
    s_bfe_u32 s9, s8, 0x10001
    s_lshl_b32 s9, s9, 3
    s_add_u32 s65, s65, s9
    s_lshl_b32 s9, s4, 1
    s_add_u32 s9, s9, s77
    s_lshl_b32 s9, s9, 5
    s_add_u32 s66, s9, s8
    v_bfe_u32 v4, v1, 4, 1
    v_mul_u32_u24 v4, 20480, v4
    v_and_b32 v5, 15, v1
    v_lshl_add_u32 v149, v5, 4, v4
    v_lshrrev_b32 v4, 5, v1
    v_lshl_add_u32 v148, v4, 8, v149
    v_lshrrev_b32 v4, 4, v1
    v_and_b32 v5, 15, v1
    v_mul_u32_u24 v5, 336, v5
    v_lshl_add_u32 v4, v4, 4, v5
    s_mul_i32 s8, s77, 21504
    s_mul_i32 s9, s76, 5376
    s_add_u32 s8, s8, s9
    s_add_u32 s8, s8, 61440
    v_add_u32 v157, s8, v4
    v_and_b32 v4, 31, v1
    v_lshrrev_b32 v5, 5, v1
    v_mul_u32_u24 v4, 336, v4
    s_mul_i32 s8, s76, 80
    s_add_u32 s8, s8, 61440
    v_add_u32 v159, s8, v4
    v_lshl_add_u32 v158, v5, 5, v159
    s_mul_i32 s8, s77, 10752
    v_add_u32 v160, s8, v158
    v_add_u32 v161, s8, v159
    s_xor_b32 s8, s8, 10752
    v_add_u32 v158, s8, v158
    v_add_u32 v159, s8, v159
    v_cmp_gt_u32 s[84:85], 32, v1
    v_mov_b32 v7, 592
    s_mul_i32 s8, s77, 5376
    s_add_u32 s8, s8, 26112
    v_lshl_add_u32 v127, v1, 4, s8
    v_and_b32 v4, 31, v1
    v_lshlrev_b32 v128, 3, v4
    v_cndmask_b32 v128, v7, v128, s[84:85]
    v_add_u32 v128, s8, v128
    v_min_u32 v6, 21, v4
    v_cmp_eq_u32 s[86:87], 24, v4
    v_lshrrev_b32 v5, 5, v1
    v_mul_u32_u24 v5, 352, v5
    v_cndmask_b32 v6, v6, 20, s[86:87]
    v_lshl_add_u32 v5, v6, 4, v5
    v_add_u32 v129, s8, v5
    v_mov_b32 v126, 0xdddddddd
    s_mul_i32 s90, s5, 160
    s_lshl_b32 s91, s79, 10
    s_add_u32 s91, s91, 61440
    s_waitcnt lgkmcnt(0)
    s_mov_b32 s48, s44
    s_mov_b32 s49, s45
    s_mov_b32 s50, 16777216
    s_mov_b32 s51, 0x20000
    s_mov_b32 s56, s18
    s_mov_b32 s57, s19
    s_mov_b32 s58, 819200
    s_mov_b32 s59, 0x20000
    s_cmp_ge_u32 s5, 4
    s_cbranch_scc1 L_duty_go
    s_setprio 0
    s_mov_b32 s82, 400000
L_w_3:
    ds_read_b32 v4, v2 offset:216
    s_waitcnt lgkmcnt(0)
    v_readfirstlane_b32 s15, v4
    s_cmp_ge_u32 s15, 4
    s_cbranch_scc1 L_wd_4
    s_sub_u32 s82, s82, 1
    s_cmp_lg_u32 s82, 0
    s_cbranch_scc1 L_w_3
L_wd_4:
    s_setprio 2
L_duty_go:
    s_setprio 3
    s_mov_b32 s52, s16
    s_mov_b32 s53, s17
    s_mov_b32 s54, 2621440
    s_mov_b32 s55, 0x20000
    s_load_dword s7, s[44:45], 0
    s_lshl_b32 s8, s71, 7
    s_add_u32 s9, s8, s88
    s_add_u32 s10, s8, s89
    buffer_load_dwordx4 v[16:19], v130, s[52:55], s9 offen
    buffer_load_dwordx4 v[20:23], v130, s[52:55], s10 offen
    s_add_u32 s8, s8, 128
    s_cmp_eq_u32 s8, 640
    s_cselect_b32 s8, 0, s8
    s_add_u32 s9, s8, s88
    s_add_u32 s10, s8, s89
    buffer_load_dwordx4 v[24:27], v130, s[52:55], s9 offen
    buffer_load_dwordx4 v[28:31], v130, s[52:55], s10 offen
    s_add_u32 s8, s8, 128
    s_cmp_eq_u32 s8, 640
    s_cselect_b32 s8, 0, s8
    s_add_u32 s9, s8, s88
    s_add_u32 s10, s8, s89
    buffer_load_dwordx4 v[32:35], v130, s[52:55], s9 offen
    buffer_load_dwordx4 v[36:39], v130, s[52:55], s10 offen
    s_add_u32 s8, s8, 128
    s_cmp_eq_u32 s8, 640
    s_cselect_b32 s8, 0, s8
    s_add_u32 s9, s8, s88
    s_add_u32 s10, s8, s89
    buffer_load_dwordx4 v[40:43], v130, s[52:55], s9 offen
    buffer_load_dwordx4 v[44:47], v130, s[52:55], s10 offen
    s_add_u32 s8, s8, 128
    s_cmp_eq_u32 s8, 640
    s_cselect_b32 s8, 0, s8
    s_add_u32 s9, s8, s88
    s_add_u32 s10, s8, s89
    buffer_load_dwordx4 v[48:51], v130, s[52:55], s9 offen
    buffer_load_dwordx4 v[52:55], v130, s[52:55], s10 offen
    s_setprio 2
    s_mul_i32 s8, s71, 81920
    s_add_u32 s8, s8, s90
    s_add_u32 s92, s90, 409600
    s_lshl_b32 s12, s79, 10
    s_sub_u32 s12, 65536, s12
    s_sub_u32 s12, s12, 61440
    s_add_u32 m0, s91, 0
    s_add_u32 s9, s8, 409600
    buffer_load_dwordx4 v124, s[56:59], s8 offen lds
    s_add_u32 m0, m0, 25600
    s_cmp_lg_u32 s79, 0
    buffer_load_dwordx4 v124, s[56:59], s9 offen lds
    s_cbranch_scc1 L_q_5
    s_add_u32 m0, m0, s12
    s_nop 0
    buffer_load_dwordx4 v125, s[56:59], s9 offen lds
    s_sub_u32 m0, m0, 25600
    s_nop 0
    buffer_load_dwordx4 v125, s[56:59], s8 offen lds
L_q_5:
    s_add_u32 s8, s8, 40960
    s_cmp_eq_u32 s8, s92
    s_cselect_b32 s8, s90, s8
    s_add_u32 m0, s91, 5120
    s_add_u32 s9, s8, 409600
    buffer_load_dwordx4 v124, s[56:59], s8 offen lds
    s_add_u32 m0, m0, 25600
    s_cmp_lg_u32 s79, 1
    buffer_load_dwordx4 v124, s[56:59], s9 offen lds
    s_cbranch_scc1 L_q_6
    s_add_u32 m0, m0, s12
    s_nop 0
    buffer_load_dwordx4 v125, s[56:59], s9 offen lds
    s_sub_u32 m0, m0, 25600
    s_nop 0
    buffer_load_dwordx4 v125, s[56:59], s8 offen lds
L_q_6:
    s_add_u32 s8, s8, 40960
    s_cmp_eq_u32 s8, s92
    s_cselect_b32 s8, s90, s8
    s_add_u32 m0, s91, 10240
    s_add_u32 s9, s8, 409600
    buffer_load_dwordx4 v124, s[56:59], s8 offen lds
    s_add_u32 m0, m0, 25600
    s_cmp_lg_u32 s79, 2
    buffer_load_dwordx4 v124, s[56:59], s9 offen lds
    s_cbranch_scc1 L_q_7
    s_add_u32 m0, m0, s12
    s_nop 0
    buffer_load_dwordx4 v125, s[56:59], s9 offen lds
    s_sub_u32 m0, m0, 25600
    s_nop 0
    buffer_load_dwordx4 v125, s[56:59], s8 offen lds
L_q_7:
    s_add_u32 s8, s8, 40960
    s_cmp_eq_u32 s8, s92
    s_cselect_b32 s8, s90, s8
    s_add_u32 m0, s91, 15360
    s_add_u32 s9, s8, 409600
    buffer_load_dwordx4 v124, s[56:59], s8 offen lds
    s_add_u32 m0, m0, 25600
    s_cmp_lg_u32 s79, 3
    buffer_load_dwordx4 v124, s[56:59], s9 offen lds
    s_cbranch_scc1 L_q_8
    s_add_u32 m0, m0, s12
    s_nop 0
    buffer_load_dwordx4 v125, s[56:59], s9 offen lds
    s_sub_u32 m0, m0, 25600
    s_nop 0
    buffer_load_dwordx4 v125, s[56:59], s8 offen lds
L_q_8:
    s_add_u32 s8, s8, 40960
    s_cmp_eq_u32 s8, s92
    s_cselect_b32 s8, s90, s8
    s_add_u32 m0, s91, 20480
    s_add_u32 s9, s8, 409600
    buffer_load_dwordx4 v124, s[56:59], s8 offen lds
    s_add_u32 m0, m0, 25600
    s_cmp_lg_u32 s79, 0
    buffer_load_dwordx4 v124, s[56:59], s9 offen lds
    s_cbranch_scc1 L_q_9
    s_add_u32 m0, m0, s12
    s_nop 0
    buffer_load_dwordx4 v125, s[56:59], s9 offen lds
    s_sub_u32 m0, m0, 25600
    s_nop 0
    buffer_load_dwordx4 v125, s[56:59], s8 offen lds
L_q_9:
    s_setprio 2
    s_mov_b64 exec, 1
    ds_add_u32 v2, v3 offset:220
    s_mov_b64 exec, -1
    s_waitcnt vmcnt(20)
    ds_write_b128 v120, v[16:19]
    ds_write_b128 v121, v[20:23] offset:1024
    ds_read_b128 v[16:19], v122
    ds_read_b128 v[20:23], v123
    s_waitcnt vmcnt(18)
    ds_write_b128 v120, v[24:27]
    ds_write_b128 v121, v[28:31] offset:1024
    ds_read_b128 v[24:27], v122
    ds_read_b128 v[28:31], v123
    s_waitcnt vmcnt(16)
    ds_write_b128 v120, v[32:35]
    ds_write_b128 v121, v[36:39] offset:1024
    ds_read_b128 v[32:35], v122
    ds_read_b128 v[36:39], v123
    s_waitcnt vmcnt(14)
    ds_write_b128 v120, v[40:43]
    ds_write_b128 v121, v[44:47] offset:1024
    ds_read_b128 v[40:43], v122
    ds_read_b128 v[44:47], v123
    s_waitcnt vmcnt(12)
    ds_write_b128 v120, v[48:51]
    ds_write_b128 v121, v[52:55] offset:1024
    ds_read_b128 v[48:51], v122
    ds_read_b128 v[52:55], v123
    s_waitcnt lgkmcnt(0)
    s_add_u32 s7, s7, 2654435769
    s_mov_b64 exec, 1
    ds_add_u32 v2, v3 offset:16
    s_mov_b64 exec, -1
    s_waitcnt vmcnt(0)
    s_mov_b64 exec, 1
    ds_add_u32 v2, v3 offset:4
    s_mov_b64 exec, -1
L_A_q:
    s_mov_b32 s60, s40
    s_mov_b32 s61, s41
    s_mov_b32 s62, 5242880
    s_mov_b32 s63, 0x20000
    s_setprio 0
    s_mov_b32 s82, 400000
L_w_10:
    ds_read_b32 v4, v2 offset:4
    s_waitcnt lgkmcnt(0)
    v_readfirstlane_b32 s15, v4
    s_cmp_ge_u32 s15, 4
    s_cbranch_scc1 L_wd_11
    s_sub_u32 s82, s82, 1
    s_cmp_lg_u32 s82, 0
    s_cbranch_scc1 L_w_10
L_wd_11:
    s_setprio 2
    ds_read_b64_tr_b16 v[80:81], v162 offset:0
    ds_read_b64_tr_b16 v[82:83], v162 offset:1280
    ds_read_b64_tr_b16 v[84:85], v162 offset:32
    ds_read_b64_tr_b16 v[86:87], v162 offset:1312
    ds_read_b64_tr_b16 v[88:89], v162 offset:64
    ds_read_b64_tr_b16 v[90:91], v162 offset:1344
    ds_read_b64_tr_b16 v[92:93], v162 offset:96
    ds_read_b64_tr_b16 v[94:95], v162 offset:1376
    ds_read_b64_tr_b16 v[96:97], v162 offset:128
    ds_read_b64_tr_b16 v[98:99], v162 offset:1408
    s_waitcnt lgkmcnt(8)
    v_mfma_f32_16x16x32_bf16 v[56:59], v[80:83], v[16:19], 0
    ds_read_b64_tr_b16 v[100:101], v162 offset:5120
    ds_read_b64_tr_b16 v[102:103], v162 offset:6400
    s_waitcnt lgkmcnt(8)
    v_mfma_f32_16x16x32_bf16 v[60:63], v[84:87], v[16:19], 0
    ds_read_b64_tr_b16 v[104:105], v162 offset:5152
    ds_read_b64_tr_b16 v[106:107], v162 offset:6432
    s_waitcnt lgkmcnt(8)
    v_mfma_f32_16x16x32_bf16 v[64:67], v[88:91], v[16:19], 0
    ds_read_b64_tr_b16 v[108:109], v162 offset:5184
    ds_read_b64_tr_b16 v[110:111], v162 offset:6464
    s_waitcnt lgkmcnt(8)
    v_mfma_f32_16x16x32_bf16 v[68:71], v[92:95], v[16:19], 0
    ds_read_b64_tr_b16 v[112:113], v162 offset:5216
    ds_read_b64_tr_b16 v[114:115], v162 offset:6496
    s_waitcnt lgkmcnt(8)
    v_mfma_f32_16x16x32_bf16 v[72:75], v[96:99], v[16:19], 0
    ds_read_b64_tr_b16 v[116:117], v162 offset:5248
    ds_read_b64_tr_b16 v[118:119], v162 offset:6528
    s_waitcnt lgkmcnt(8)
    v_mfma_f32_16x16x32_bf16 v[56:59], v[100:103], v[20:23], v[56:59]
    ds_read_b64_tr_b16 v[80:81], v162 offset:10240
    ds_read_b64_tr_b16 v[82:83], v162 offset:11520
    s_waitcnt lgkmcnt(8)
    v_mfma_f32_16x16x32_bf16 v[60:63], v[104:107], v[20:23], v[60:63]
    ds_read_b64_tr_b16 v[84:85], v162 offset:10272
    ds_read_b64_tr_b16 v[86:87], v162 offset:11552
    s_waitcnt lgkmcnt(8)
    v_mfma_f32_16x16x32_bf16 v[64:67], v[108:111], v[20:23], v[64:67]
    ds_read_b64_tr_b16 v[88:89], v162 offset:10304
    ds_read_b64_tr_b16 v[90:91], v162 offset:11584
    s_waitcnt lgkmcnt(8)
    v_mfma_f32_16x16x32_bf16 v[68:71], v[112:115], v[20:23], v[68:71]
    ds_read_b64_tr_b16 v[92:93], v162 offset:10336
    ds_read_b64_tr_b16 v[94:95], v162 offset:11616
    s_waitcnt lgkmcnt(8)
    v_mfma_f32_16x16x32_bf16 v[72:75], v[116:119], v[20:23], v[72:75]
    ds_read_b64_tr_b16 v[96:97], v162 offset:10368
    ds_read_b64_tr_b16 v[98:99], v162 offset:11648
    s_waitcnt lgkmcnt(8)
    v_mfma_f32_16x16x32_bf16 v[56:59], v[80:83], v[24:27], v[56:59]
    ds_read_b64_tr_b16 v[100:101], v162 offset:15360
    ds_read_b64_tr_b16 v[102:103], v162 offset:16640
    s_waitcnt lgkmcnt(8)
    v_mfma_f32_16x16x32_bf16 v[60:63], v[84:87], v[24:27], v[60:63]
    ds_read_b64_tr_b16 v[104:105], v162 offset:15392
    ds_read_b64_tr_b16 v[106:107], v162 offset:16672
    s_waitcnt lgkmcnt(8)
    v_mfma_f32_16x16x32_bf16 v[64:67], v[88:91], v[24:27], v[64:67]
    ds_read_b64_tr_b16 v[108:109], v162 offset:15424
    ds_read_b64_tr_b16 v[110:111], v162 offset:16704
    s_waitcnt lgkmcnt(8)
    v_mfma_f32_16x16x32_bf16 v[68:71], v[92:95], v[24:27], v[68:71]
    ds_read_b64_tr_b16 v[112:113], v162 offset:15456
    ds_read_b64_tr_b16 v[114:115], v162 offset:16736
    s_waitcnt lgkmcnt(8)
    v_mfma_f32_16x16x32_bf16 v[72:75], v[96:99], v[24:27], v[72:75]
    ds_read_b64_tr_b16 v[116:117], v162 offset:15488
    ds_read_b64_tr_b16 v[118:119], v162 offset:16768
    s_waitcnt lgkmcnt(8)
    v_mfma_f32_16x16x32_bf16 v[56:59], v[100:103], v[28:31], v[56:59]
    ds_read_b64_tr_b16 v[80:81], v162 offset:20480
    ds_read_b64_tr_b16 v[82:83], v162 offset:21760
    s_waitcnt lgkmcnt(8)
    v_mfma_f32_16x16x32_bf16 v[60:63], v[104:107], v[28:31], v[60:63]
    ds_read_b64_tr_b16 v[84:85], v162 offset:20512
    ds_read_b64_tr_b16 v[86:87], v162 offset:21792
    s_waitcnt lgkmcnt(8)
    v_mfma_f32_16x16x32_bf16 v[64:67], v[108:111], v[28:31], v[64:67]
    ds_read_b64_tr_b16 v[88:89], v162 offset:20544
    ds_read_b64_tr_b16 v[90:91], v162 offset:21824
    s_waitcnt lgkmcnt(8)
    v_mfma_f32_16x16x32_bf16 v[68:71], v[112:115], v[28:31], v[68:71]
    ds_read_b64_tr_b16 v[92:93], v162 offset:20576
    ds_read_b64_tr_b16 v[94:95], v162 offset:21856
    s_waitcnt lgkmcnt(8)
    v_mfma_f32_16x16x32_bf16 v[72:75], v[116:119], v[28:31], v[72:75]
    ds_read_b64_tr_b16 v[96:97], v162 offset:20608
    ds_read_b64_tr_b16 v[98:99], v162 offset:21888
    s_waitcnt lgkmcnt(8)
    v_mfma_f32_16x16x32_bf16 v[56:59], v[80:83], v[32:35], v[56:59]
    s_waitcnt lgkmcnt(6)
    v_mfma_f32_16x16x32_bf16 v[60:63], v[84:87], v[32:35], v[60:63]
    s_waitcnt lgkmcnt(4)
    v_mfma_f32_16x16x32_bf16 v[64:67], v[88:91], v[32:35], v[64:67]
    s_waitcnt lgkmcnt(2)
    v_mfma_f32_16x16x32_bf16 v[68:71], v[92:95], v[32:35], v[68:71]
    s_waitcnt lgkmcnt(0)
    v_mfma_f32_16x16x32_bf16 v[72:75], v[96:99], v[32:35], v[72:75]
    s_mov_b64 exec, 1
    ds_add_u32 v2, v3 offset:8
    s_mov_b64 exec, -1
    v_add_u32 v162, 51200, v162
    s_setprio 0
    s_mov_b32 s82, 400000
L_w_12:
    ds_read_b32 v4, v2 offset:8
    s_waitcnt lgkmcnt(0)
    v_readfirstlane_b32 s15, v4
    s_cmp_ge_u32 s15, 9
    s_cbranch_scc1 L_wd_13
    s_sub_u32 s82, s82, 1
    s_cmp_lg_u32 s82, 0
    s_cbranch_scc1 L_w_12
L_wd_13:
    s_setprio 2
    ds_read_b64_tr_b16 v[100:101], v162 offset:0
    ds_read_b64_tr_b16 v[102:103], v162 offset:1280
    ds_read_b64_tr_b16 v[104:105], v162 offset:32
    ds_read_b64_tr_b16 v[106:107], v162 offset:1312
    ds_read_b64_tr_b16 v[108:109], v162 offset:64
    ds_read_b64_tr_b16 v[110:111], v162 offset:1344
    ds_read_b64_tr_b16 v[112:113], v162 offset:96
    ds_read_b64_tr_b16 v[114:115], v162 offset:1376
    ds_read_b64_tr_b16 v[116:117], v162 offset:128
    ds_read_b64_tr_b16 v[118:119], v162 offset:1408
    s_waitcnt lgkmcnt(8)
    v_mfma_f32_16x16x32_bf16 v[56:59], v[100:103], v[36:39], v[56:59]
    ds_read_b64_tr_b16 v[80:81], v162 offset:5120
    ds_read_b64_tr_b16 v[82:83], v162 offset:6400
    s_waitcnt lgkmcnt(8)
    v_mfma_f32_16x16x32_bf16 v[60:63], v[104:107], v[36:39], v[60:63]
    ds_read_b64_tr_b16 v[84:85], v162 offset:5152
    ds_read_b64_tr_b16 v[86:87], v162 offset:6432
    s_waitcnt lgkmcnt(8)
    v_mfma_f32_16x16x32_bf16 v[64:67], v[108:111], v[36:39], v[64:67]
    ds_read_b64_tr_b16 v[88:89], v162 offset:5184
    ds_read_b64_tr_b16 v[90:91], v162 offset:6464
    s_waitcnt lgkmcnt(8)
    v_mfma_f32_16x16x32_bf16 v[68:71], v[112:115], v[36:39], v[68:71]
    ds_read_b64_tr_b16 v[92:93], v162 offset:5216
    ds_read_b64_tr_b16 v[94:95], v162 offset:6496
    s_waitcnt lgkmcnt(8)
    v_mfma_f32_16x16x32_bf16 v[72:75], v[116:119], v[36:39], v[72:75]
    ds_read_b64_tr_b16 v[96:97], v162 offset:5248
    ds_read_b64_tr_b16 v[98:99], v162 offset:6528
    s_waitcnt lgkmcnt(8)
    v_mfma_f32_16x16x32_bf16 v[56:59], v[80:83], v[40:43], v[56:59]
    ds_read_b64_tr_b16 v[100:101], v162 offset:10240
    ds_read_b64_tr_b16 v[102:103], v162 offset:11520
    s_waitcnt lgkmcnt(8)
    v_mfma_f32_16x16x32_bf16 v[60:63], v[84:87], v[40:43], v[60:63]
    ds_read_b64_tr_b16 v[104:105], v162 offset:10272
    ds_read_b64_tr_b16 v[106:107], v162 offset:11552
    s_waitcnt lgkmcnt(8)
    v_mfma_f32_16x16x32_bf16 v[64:67], v[88:91], v[40:43], v[64:67]
    ds_read_b64_tr_b16 v[108:109], v162 offset:10304
    ds_read_b64_tr_b16 v[110:111], v162 offset:11584
    s_waitcnt lgkmcnt(8)
    v_mfma_f32_16x16x32_bf16 v[68:71], v[92:95], v[40:43], v[68:71]
    ds_read_b64_tr_b16 v[112:113], v162 offset:10336
    ds_read_b64_tr_b16 v[114:115], v162 offset:11616
    s_waitcnt lgkmcnt(8)
    v_mfma_f32_16x16x32_bf16 v[72:75], v[96:99], v[40:43], v[72:75]
    ds_read_b64_tr_b16 v[116:117], v162 offset:10368
    ds_read_b64_tr_b16 v[118:119], v162 offset:11648
    s_waitcnt lgkmcnt(8)
    v_mfma_f32_16x16x32_bf16 v[56:59], v[100:103], v[44:47], v[56:59]
    ds_read_b64_tr_b16 v[80:81], v162 offset:15360
    ds_read_b64_tr_b16 v[82:83], v162 offset:16640
    s_waitcnt lgkmcnt(8)
    v_mfma_f32_16x16x32_bf16 v[60:63], v[104:107], v[44:47], v[60:63]
    ds_read_b64_tr_b16 v[84:85], v162 offset:15392
    ds_read_b64_tr_b16 v[86:87], v162 offset:16672
    s_waitcnt lgkmcnt(8)
    v_mfma_f32_16x16x32_bf16 v[64:67], v[108:111], v[44:47], v[64:67]
    ds_read_b64_tr_b16 v[88:89], v162 offset:15424
    ds_read_b64_tr_b16 v[90:91], v162 offset:16704
    s_waitcnt lgkmcnt(8)
    v_mfma_f32_16x16x32_bf16 v[68:71], v[112:115], v[44:47], v[68:71]
    ds_read_b64_tr_b16 v[92:93], v162 offset:15456
    ds_read_b64_tr_b16 v[94:95], v162 offset:16736
    s_waitcnt lgkmcnt(8)
    v_mfma_f32_16x16x32_bf16 v[72:75], v[116:119], v[44:47], v[72:75]
    ds_read_b64_tr_b16 v[96:97], v162 offset:15488
    ds_read_b64_tr_b16 v[98:99], v162 offset:16768
    s_waitcnt lgkmcnt(8)
    v_mfma_f32_16x16x32_bf16 v[56:59], v[80:83], v[48:51], v[56:59]
    ds_read_b64_tr_b16 v[100:101], v162 offset:20480
    ds_read_b64_tr_b16 v[102:103], v162 offset:21760
    s_waitcnt lgkmcnt(8)
    v_mfma_f32_16x16x32_bf16 v[60:63], v[84:87], v[48:51], v[60:63]
    ds_read_b64_tr_b16 v[104:105], v162 offset:20512
    ds_read_b64_tr_b16 v[106:107], v162 offset:21792
    s_waitcnt lgkmcnt(8)
    v_mfma_f32_16x16x32_bf16 v[64:67], v[88:91], v[48:51], v[64:67]
    ds_read_b64_tr_b16 v[108:109], v162 offset:20544
    ds_read_b64_tr_b16 v[110:111], v162 offset:21824
    s_waitcnt lgkmcnt(8)
    v_mfma_f32_16x16x32_bf16 v[68:71], v[92:95], v[48:51], v[68:71]
    ds_read_b64_tr_b16 v[112:113], v162 offset:20576
    ds_read_b64_tr_b16 v[114:115], v162 offset:21856
    s_waitcnt lgkmcnt(8)
    v_mfma_f32_16x16x32_bf16 v[72:75], v[96:99], v[48:51], v[72:75]
    ds_read_b64_tr_b16 v[116:117], v162 offset:20608
    ds_read_b64_tr_b16 v[118:119], v162 offset:21888
    s_waitcnt lgkmcnt(8)
    v_mfma_f32_16x16x32_bf16 v[56:59], v[100:103], v[52:55], v[56:59]
    s_waitcnt lgkmcnt(6)
    v_mfma_f32_16x16x32_bf16 v[60:63], v[104:107], v[52:55], v[60:63]
    s_waitcnt lgkmcnt(4)
    v_mfma_f32_16x16x32_bf16 v[64:67], v[108:111], v[52:55], v[64:67]
    s_waitcnt lgkmcnt(2)
    v_mfma_f32_16x16x32_bf16 v[68:71], v[112:115], v[52:55], v[68:71]
    s_waitcnt lgkmcnt(0)
    v_mfma_f32_16x16x32_bf16 v[72:75], v[116:119], v[52:55], v[72:75]
    ds_write_b128 v157, v[56:59] offset:0
    s_nop 0
    ds_write_b128 v157, v[60:63] offset:64
    s_nop 0
    ds_write_b128 v157, v[64:67] offset:128
    s_nop 0
    ds_write_b128 v157, v[68:71] offset:192
    s_nop 0
    ds_write_b128 v157, v[72:75] offset:256
    s_waitcnt lgkmcnt(0)
    s_mov_b64 exec, 1
    ds_add_u32 v2, v3 offset:12
    s_mov_b64 exec, -1
    v_cmp_gt_u32 s[84:85], 32, v1
    v_mov_b64 v[48:49], 0
    v_mov_b64 v[50:51], 0
    v_mov_b64 v[52:53], 0
    v_mov_b64 v[54:55], 0
    v_mov_b64 v[56:57], 0
    v_mov_b64 v[58:59], 0
    v_mov_b64 v[60:61], 0
    v_mov_b64 v[62:63], 0
    v_mov_b64 v[64:65], 0
    v_mov_b64 v[66:67], 0
    v_mov_b64 v[68:69], 0
    v_mov_b64 v[70:71], 0
    v_mov_b64 v[72:73], 0
    v_mov_b64 v[74:75], 0
    v_mov_b64 v[76:77], 0
    v_mov_b64 v[78:79], 0
    v_mov_b64 v[108:109], 0
    v_mov_b64 v[110:111], 0
    s_setprio 0
    s_mov_b32 s82, 400000
L_w_14:
    ds_read_b32 v4, v2 offset:12
    s_waitcnt lgkmcnt(0)
    v_readfirstlane_b32 s15, v4
    s_cmp_ge_u32 s15, 8
    s_cbranch_scc1 L_wd_15
    s_sub_u32 s82, s82, 1
    s_cmp_lg_u32 s82, 0
    s_cbranch_scc1 L_w_14
L_wd_15:
    s_setprio 2
    ds_read_b128 v[16:19], v160
    ds_read_b128 v[20:23], v160 offset:16
    ds_read_b128 v[24:27], v161 offset:64
    ds_read_b128 v[28:31], v160 offset:21504
    ds_read_b128 v[32:35], v160 offset:21520
    ds_read_b128 v[36:39], v161 offset:21568
    ds_read_b128 v[80:83], v158
    ds_read_b128 v[84:87], v158 offset:16
    ds_read_b128 v[88:91], v159 offset:64
    ds_read_b128 v[92:95], v158 offset:21504
    ds_read_b128 v[96:99], v158 offset:21520
    ds_read_b128 v[100:103], v159 offset:21568
    s_waitcnt lgkmcnt(6)
    v_pk_add_f32 v[16:17], v[16:17], v[28:29]
    v_pk_add_f32 v[18:19], v[18:19], v[30:31]
    v_pk_add_f32 v[20:21], v[20:21], v[32:33]
    v_pk_add_f32 v[22:23], v[22:23], v[34:35]
    v_pk_add_f32 v[24:25], v[24:25], v[36:37]
    v_pk_add_f32 v[26:27], v[26:27], v[38:39]
    v_cvt_pk_bf16_f32 v112, v16, v17
    v_cvt_pk_bf16_f32 v113, v18, v19
    v_cvt_pk_bf16_f32 v114, v20, v21
    v_cvt_pk_bf16_f32 v115, v22, v23
    v_cvt_pk_bf16_f32 v116, v24, v25
    v_cvt_pk_bf16_f32 v117, v26, v27
    v_cndmask_b32 v116, 0, v116, s[84:85]
    v_cndmask_b32 v117, 0, v117, s[84:85]
    v_dot2_f32_bf16 v13, v112, v112, 0
    v_dot2_f32_bf16 v13, v113, v113, v13
    v_dot2_f32_bf16 v13, v114, v114, v13
    v_dot2_f32_bf16 v13, v115, v115, v13
    v_dot2_f32_bf16 v13, v116, v116, v13
    v_dot2_f32_bf16 v13, v117, v117, v13
    s_waitcnt lgkmcnt(0)
    v_pk_add_f32 v[80:81], v[80:81], v[92:93]
    v_pk_add_f32 v[82:83], v[82:83], v[94:95]
    v_pk_add_f32 v[84:85], v[84:85], v[96:97]
    v_pk_add_f32 v[86:87], v[86:87], v[98:99]
    v_pk_add_f32 v[88:89], v[88:89], v[100:101]
    v_pk_add_f32 v[90:91], v[90:91], v[102:103]
    v_cvt_pk_bf16_f32 v120, v80, v81
    v_cvt_pk_bf16_f32 v121, v82, v83
    v_cvt_pk_bf16_f32 v122, v84, v85
    v_cvt_pk_bf16_f32 v123, v86, v87
    v_cvt_pk_bf16_f32 v124, v88, v89
    v_cvt_pk_bf16_f32 v125, v90, v91
    v_cndmask_b32 v124, 0, v124, s[84:85]
    v_cndmask_b32 v125, 0, v125, s[84:85]
    v_dot2_f32_bf16 v13, v120, v120, v13
    v_dot2_f32_bf16 v13, v121, v121, v13
    v_dot2_f32_bf16 v13, v122, v122, v13
    v_dot2_f32_bf16 v13, v123, v123, v13
    v_dot2_f32_bf16 v13, v124, v124, v13
    v_dot2_f32_bf16 v13, v125, v125, v13
    s_mov_b64 exec, 1
    ds_add_u32 v2, v3 offset:136
    s_mov_b64 exec, -1
    v_mov_b64 v[40:41], 0
    v_mov_b64 v[42:43], 0
    v_mov_b64 v[44:45], 0
    v_mov_b64 v[46:47], 0
    v_mov_b32 v15, v13
    s_nop 1
    v_permlane32_swap_b32 v13, v15
    v_add_f32 v13, v13, v15
    v_rcp_f32 v13, v13
    s_nop 0
    v_mul_f32 v130, 0x455ac000, v13
    v_add_u32 v155, 256, v2
    s_setprio 0
    s_mov_b32 s82, 400000
L_g_16:
    ds_read_b32 v131, v155 offset:0
    s_waitcnt lgkmcnt(0)
    v_readfirstlane_b32 s15, v131
    s_cmp_lg_u32 s15, -1
    s_cbranch_scc1 L_gd_17
    s_sub_u32 s82, s82, 1
    s_cmp_lg_u32 s82, 0
    s_cbranch_scc1 L_g_16
L_gd_17:
    ds_read_b128 v[80:83], v127 offset:0
    ds_read_b64 v[84:85], v128 offset:1024
    ds_read_b128 v[96:99], v129 offset:1280
    ds_read_b128 v[100:103], v129 offset:1984
    s_setprio 3
    s_mov_b32 s83, 0
    v_mov_b32 v132, 0xff7fffff
    v_mov_b32 v133, 0xff7fffff
    s_waitcnt lgkmcnt(2)
    v_cmp_nle_f32 vcc, v131, v130
    s_cbranch_vccnz L_slow
    s_mov_b32 s93, 0
    v_mfma_f32_32x32x16_bf16 v[16:31], v[80:83], v[112:115], 0
    v_mfma_f32_32x32x8bf16_1k v[16:31], v[84:85], v[116:117], v[16:31]
    s_waitcnt lgkmcnt(0)
    s_nop 7
.p2align 6
L_attn:
    v_smfmac_f32_32x32x32_bf16 v[64:79], v[108:111], v[40:47], v126
    ds_read_b32 v131, v155 offset:4
    ds_read_b128 v[88:91], v127 offset:2688
    ds_read_b64 v[92:93], v128 offset:3712
    v_exp_f32 v16, v16
    v_exp_f32 v17, v17
    v_exp_f32 v18, v18
    v_mfma_f32_32x32x16_bf16 v[32:47], v[80:83], v[120:123], 0
    v_exp_f32 v19, v19
    v_exp_f32 v20, v20
    v_exp_f32 v21, v21
    v_exp_f32 v22, v22
    v_mfma_f32_32x32x8bf16_1k v[32:47], v[84:85], v[124:125], v[32:47]
    v_exp_f32 v23, v23
    v_exp_f32 v24, v24
    v_exp_f32 v25, v25
    v_exp_f32 v26, v26
    v_smfmac_f32_32x32x32_bf16 v[48:63], v[96:99], v[16:23], v126
    v_exp_f32 v27, v27
    v_exp_f32 v28, v28
    v_exp_f32 v29, v29
    v_exp_f32 v30, v30
    v_exp_f32 v31, v31
    ds_read_b128 v[104:107], v129 offset:3968
    ds_read_b128 v[108:111], v129 offset:4672
    v_exp_f32 v32, v32
    v_smfmac_f32_32x32x32_bf16 v[48:63], v[100:103], v[24:31], v126
    v_exp_f32 v33, v33
    v_exp_f32 v34, v34
    v_exp_f32 v35, v35
    s_waitcnt lgkmcnt(2)
    v_mfma_f32_32x32x16_bf16 v[16:31], v[88:91], v[112:115], 0
    v_exp_f32 v36, v36
    v_exp_f32 v37, v37
    v_exp_f32 v38, v38
    v_exp_f32 v39, v39
    v_mfma_f32_32x32x8bf16_1k v[16:31], v[92:93], v[116:117], v[16:31]
    v_exp_f32 v40, v40
    v_exp_f32 v41, v41
    v_exp_f32 v42, v42
    v_exp_f32 v43, v43
    v_smfmac_f32_32x32x32_bf16 v[64:79], v[96:99], v[32:39], v126
    v_exp_f32 v44, v44
    v_exp_f32 v45, v45
    v_exp_f32 v46, v46
    v_exp_f32 v47, v47
    s_waitcnt lgkmcnt(0)
    v_cmp_nle_f32 vcc, v131, v130
    s_mov_b64 exec, 1
    ds_add_u32 v2, v3 offset:336
    s_mov_b64 exec, -1
    s_cbranch_vccnz L_chk0
L_ret0:
    s_setprio 2
    v_smfmac_f32_32x32x32_bf16 v[64:79], v[100:103], v[40:47], v126
    ds_read_b128 v[80:83], v127 offset:10752
    ds_read_b64 v[84:85], v128 offset:11776
    v_exp_f32 v16, v16
    v_exp_f32 v17, v17
    v_exp_f32 v18, v18
    v_mfma_f32_32x32x16_bf16 v[32:47], v[88:91], v[120:123], 0
    v_exp_f32 v19, v19
    v_exp_f32 v20, v20
    v_exp_f32 v21, v21
    v_exp_f32 v22, v22
    v_mfma_f32_32x32x8bf16_1k v[32:47], v[92:93], v[124:125], v[32:47]
    v_exp_f32 v23, v23
    v_exp_f32 v24, v24
    v_exp_f32 v25, v25
    v_exp_f32 v26, v26
    v_smfmac_f32_32x32x32_bf16 v[48:63], v[104:107], v[16:23], v126
    v_exp_f32 v27, v27
    v_exp_f32 v28, v28
    v_exp_f32 v29, v29
    v_exp_f32 v30, v30
    v_exp_f32 v31, v31
    ds_read_b128 v[96:99], v129 offset:12032
    ds_read_b128 v[100:103], v129 offset:12736
    v_exp_f32 v32, v32
    v_smfmac_f32_32x32x32_bf16 v[48:63], v[108:111], v[24:31], v126
    v_exp_f32 v33, v33
    v_exp_f32 v34, v34
    v_exp_f32 v35, v35
    s_waitcnt lgkmcnt(2)
    v_mfma_f32_32x32x16_bf16 v[16:31], v[80:83], v[112:115], 0
    v_exp_f32 v36, v36
    v_exp_f32 v37, v37
    v_exp_f32 v38, v38
    v_exp_f32 v39, v39
    v_mfma_f32_32x32x8bf16_1k v[16:31], v[84:85], v[116:117], v[16:31]
    v_exp_f32 v40, v40
    v_exp_f32 v41, v41
    v_exp_f32 v42, v42
    v_exp_f32 v43, v43
    v_smfmac_f32_32x32x32_bf16 v[64:79], v[104:107], v[32:39], v126
    v_exp_f32 v44, v44
    v_exp_f32 v45, v45
    v_exp_f32 v46, v46
    v_exp_f32 v47, v47
    s_waitcnt lgkmcnt(0)
    s_nop 0
    v_smfmac_f32_32x32x32_bf16 v[64:79], v[108:111], v[40:47], v126
    ds_read_b32 v131, v155 offset:8
    ds_read_b128 v[88:91], v127 offset:13440
    ds_read_b64 v[92:93], v128 offset:14464
    v_exp_f32 v16, v16
    v_exp_f32 v17, v17
    v_exp_f32 v18, v18
    v_mfma_f32_32x32x16_bf16 v[32:47], v[80:83], v[120:123], 0
    v_exp_f32 v19, v19
    v_exp_f32 v20, v20
    v_exp_f32 v21, v21
    v_exp_f32 v22, v22
    v_mfma_f32_32x32x8bf16_1k v[32:47], v[84:85], v[124:125], v[32:47]
    v_exp_f32 v23, v23
    v_exp_f32 v24, v24
    v_exp_f32 v25, v25
    v_exp_f32 v26, v26
    v_smfmac_f32_32x32x32_bf16 v[48:63], v[96:99], v[16:23], v126
    v_exp_f32 v27, v27
    v_exp_f32 v28, v28
    v_exp_f32 v29, v29
    v_exp_f32 v30, v30
    v_exp_f32 v31, v31
    ds_read_b128 v[104:107], v129 offset:14720
    ds_read_b128 v[108:111], v129 offset:15424
    v_exp_f32 v32, v32
    v_smfmac_f32_32x32x32_bf16 v[48:63], v[100:103], v[24:31], v126
    v_exp_f32 v33, v33
    v_exp_f32 v34, v34
    v_exp_f32 v35, v35
    s_waitcnt lgkmcnt(2)
    v_mfma_f32_32x32x16_bf16 v[16:31], v[88:91], v[112:115], 0
    v_exp_f32 v36, v36
    v_exp_f32 v37, v37
    v_exp_f32 v38, v38
    v_exp_f32 v39, v39
    v_mfma_f32_32x32x8bf16_1k v[16:31], v[92:93], v[116:117], v[16:31]
    v_exp_f32 v40, v40
    v_exp_f32 v41, v41
    v_exp_f32 v42, v42
    v_exp_f32 v43, v43
    v_smfmac_f32_32x32x32_bf16 v[64:79], v[96:99], v[32:39], v126
    v_exp_f32 v44, v44
    v_exp_f32 v45, v45
    v_exp_f32 v46, v46
    v_exp_f32 v47, v47
    s_waitcnt lgkmcnt(0)
    v_cmp_nle_f32 vcc, v131, v130
    s_mov_b64 exec, 1
    ds_add_u32 v2, v3 offset:340
    s_mov_b64 exec, -1
    s_cbranch_vccnz L_chk1
L_ret1:
    s_setprio 1
    v_smfmac_f32_32x32x32_bf16 v[64:79], v[100:103], v[40:47], v126
    ds_read_b128 v[80:83], v127 offset:35328
    ds_read_b64 v[84:85], v128 offset:36352
    v_exp_f32 v16, v16
    v_exp_f32 v17, v17
    v_exp_f32 v18, v18
    v_mfma_f32_32x32x16_bf16 v[32:47], v[88:91], v[120:123], 0
    v_exp_f32 v19, v19
    v_exp_f32 v20, v20
    v_exp_f32 v21, v21
    v_exp_f32 v22, v22
    v_mfma_f32_32x32x8bf16_1k v[32:47], v[92:93], v[124:125], v[32:47]
    v_exp_f32 v23, v23
    v_exp_f32 v24, v24
    v_exp_f32 v25, v25
    v_exp_f32 v26, v26
    v_smfmac_f32_32x32x32_bf16 v[48:63], v[104:107], v[16:23], v126
    v_exp_f32 v27, v27
    v_exp_f32 v28, v28
    v_exp_f32 v29, v29
    v_exp_f32 v30, v30
    v_exp_f32 v31, v31
    ds_read_b128 v[96:99], v129 offset:36608
    ds_read_b128 v[100:103], v129 offset:37312
    v_exp_f32 v32, v32
    v_smfmac_f32_32x32x32_bf16 v[48:63], v[108:111], v[24:31], v126
    v_exp_f32 v33, v33
    v_exp_f32 v34, v34
    v_exp_f32 v35, v35
    s_waitcnt lgkmcnt(2)
    v_mfma_f32_32x32x16_bf16 v[16:31], v[80:83], v[112:115], 0
    v_exp_f32 v36, v36
    v_exp_f32 v37, v37
    v_exp_f32 v38, v38
    v_exp_f32 v39, v39
    v_mfma_f32_32x32x8bf16_1k v[16:31], v[84:85], v[116:117], v[16:31]
    v_exp_f32 v40, v40
    v_exp_f32 v41, v41
    v_exp_f32 v42, v42
    v_exp_f32 v43, v43
    v_smfmac_f32_32x32x32_bf16 v[64:79], v[104:107], v[32:39], v126
    v_exp_f32 v44, v44
    v_exp_f32 v45, v45
    v_exp_f32 v46, v46
    v_exp_f32 v47, v47
    s_waitcnt lgkmcnt(0)
    s_nop 0
    v_smfmac_f32_32x32x32_bf16 v[64:79], v[108:111], v[40:47], v126
    ds_read_b32 v131, v155 offset:12
    ds_read_b128 v[88:91], v127 offset:38016
    ds_read_b64 v[92:93], v128 offset:39040
    v_exp_f32 v16, v16
    v_exp_f32 v17, v17
    v_exp_f32 v18, v18
    v_mfma_f32_32x32x16_bf16 v[32:47], v[80:83], v[120:123], 0
    v_exp_f32 v19, v19
    v_exp_f32 v20, v20
    v_exp_f32 v21, v21
    v_exp_f32 v22, v22
    v_mfma_f32_32x32x8bf16_1k v[32:47], v[84:85], v[124:125], v[32:47]
    v_exp_f32 v23, v23
    v_exp_f32 v24, v24
    v_exp_f32 v25, v25
    v_exp_f32 v26, v26
    v_smfmac_f32_32x32x32_bf16 v[48:63], v[96:99], v[16:23], v126
    v_exp_f32 v27, v27
    v_exp_f32 v28, v28
    v_exp_f32 v29, v29
    v_exp_f32 v30, v30
    v_exp_f32 v31, v31
    ds_read_b128 v[104:107], v129 offset:39296
    ds_read_b128 v[108:111], v129 offset:40000
    v_exp_f32 v32, v32
    v_smfmac_f32_32x32x32_bf16 v[48:63], v[100:103], v[24:31], v126
    v_exp_f32 v33, v33
    v_exp_f32 v34, v34
    v_exp_f32 v35, v35
    s_waitcnt lgkmcnt(2)
    v_mfma_f32_32x32x16_bf16 v[16:31], v[88:91], v[112:115], 0
    v_exp_f32 v36, v36
    v_exp_f32 v37, v37
    v_exp_f32 v38, v38
    v_exp_f32 v39, v39
    v_mfma_f32_32x32x8bf16_1k v[16:31], v[92:93], v[116:117], v[16:31]
    v_exp_f32 v40, v40
    v_exp_f32 v41, v41
    v_exp_f32 v42, v42
    v_exp_f32 v43, v43
    v_smfmac_f32_32x32x32_bf16 v[64:79], v[96:99], v[32:39], v126
    v_exp_f32 v44, v44
    v_exp_f32 v45, v45
    v_exp_f32 v46, v46
    v_exp_f32 v47, v47
    s_waitcnt lgkmcnt(0)
    v_cmp_nle_f32 vcc, v131, v130
    s_mov_b64 exec, 1
    ds_add_u32 v2, v3 offset:344
    s_mov_b64 exec, -1
    s_cbranch_vccnz L_chk2
L_ret2:
    s_setprio 0
    v_smfmac_f32_32x32x32_bf16 v[64:79], v[100:103], v[40:47], v126
    ds_read_b128 v[80:83], v127 offset:46080
    ds_read_b64 v[84:85], v128 offset:47104
    v_exp_f32 v16, v16
    v_exp_f32 v17, v17
    v_exp_f32 v18, v18
    v_mfma_f32_32x32x16_bf16 v[32:47], v[88:91], v[120:123], 0
    v_exp_f32 v19, v19
    v_exp_f32 v20, v20
    v_exp_f32 v21, v21
    v_exp_f32 v22, v22
    v_mfma_f32_32x32x8bf16_1k v[32:47], v[92:93], v[124:125], v[32:47]
    v_exp_f32 v23, v23
    v_exp_f32 v24, v24
    v_exp_f32 v25, v25
    v_exp_f32 v26, v26
    v_smfmac_f32_32x32x32_bf16 v[48:63], v[104:107], v[16:23], v126
    v_exp_f32 v27, v27
    v_exp_f32 v28, v28
    v_exp_f32 v29, v29
    v_exp_f32 v30, v30
    v_exp_f32 v31, v31
    ds_read_b128 v[96:99], v129 offset:47360
    ds_read_b128 v[100:103], v129 offset:48064
    v_exp_f32 v32, v32
    v_smfmac_f32_32x32x32_bf16 v[48:63], v[108:111], v[24:31], v126
    v_exp_f32 v33, v33
    v_exp_f32 v34, v34
    v_exp_f32 v35, v35
    s_waitcnt lgkmcnt(2)
    v_mfma_f32_32x32x16_bf16 v[16:31], v[80:83], v[112:115], 0
    v_exp_f32 v36, v36
    v_exp_f32 v37, v37
    v_exp_f32 v38, v38
    v_exp_f32 v39, v39
    v_mfma_f32_32x32x8bf16_1k v[16:31], v[84:85], v[116:117], v[16:31]
    v_exp_f32 v40, v40
    v_exp_f32 v41, v41
    v_exp_f32 v42, v42
    v_exp_f32 v43, v43
    v_smfmac_f32_32x32x32_bf16 v[64:79], v[104:107], v[32:39], v126
    v_exp_f32 v44, v44
    v_exp_f32 v45, v45
    v_exp_f32 v46, v46
    v_exp_f32 v47, v47
    s_waitcnt lgkmcnt(0)
    s_nop 0
    v_smfmac_f32_32x32x32_bf16 v[64:79], v[108:111], v[40:47], v126
    ds_read_b32 v131, v155 offset:16
    ds_read_b128 v[88:91], v127 offset:48768
    ds_read_b64 v[92:93], v128 offset:49792
    v_exp_f32 v16, v16
    v_exp_f32 v17, v17
    v_exp_f32 v18, v18
    v_mfma_f32_32x32x16_bf16 v[32:47], v[80:83], v[120:123], 0
    v_exp_f32 v19, v19
    v_exp_f32 v20, v20
    v_exp_f32 v21, v21
    v_exp_f32 v22, v22
    v_mfma_f32_32x32x8bf16_1k v[32:47], v[84:85], v[124:125], v[32:47]
    v_exp_f32 v23, v23
    v_exp_f32 v24, v24
    v_exp_f32 v25, v25
    v_exp_f32 v26, v26
    v_smfmac_f32_32x32x32_bf16 v[48:63], v[96:99], v[16:23], v126
    v_exp_f32 v27, v27
    v_exp_f32 v28, v28
    v_exp_f32 v29, v29
    v_exp_f32 v30, v30
    v_exp_f32 v31, v31
    ds_read_b128 v[104:107], v129 offset:50048
    ds_read_b128 v[108:111], v129 offset:50752
    v_exp_f32 v32, v32
    v_smfmac_f32_32x32x32_bf16 v[48:63], v[100:103], v[24:31], v126
    v_exp_f32 v33, v33
    v_exp_f32 v34, v34
    v_exp_f32 v35, v35
    s_waitcnt lgkmcnt(2)
    v_mfma_f32_32x32x16_bf16 v[16:31], v[88:91], v[112:115], 0
    v_exp_f32 v36, v36
    v_exp_f32 v37, v37
    v_exp_f32 v38, v38
    v_exp_f32 v39, v39
    v_mfma_f32_32x32x8bf16_1k v[16:31], v[92:93], v[116:117], v[16:31]
    v_exp_f32 v40, v40
    v_exp_f32 v41, v41
    v_exp_f32 v42, v42
    v_exp_f32 v43, v43
    v_smfmac_f32_32x32x32_bf16 v[64:79], v[96:99], v[32:39], v126
    v_exp_f32 v44, v44
    v_exp_f32 v45, v45
    v_exp_f32 v46, v46
    v_exp_f32 v47, v47
    s_waitcnt lgkmcnt(0)
    v_cmp_nle_f32 vcc, v131, v130
    s_mov_b64 exec, 1
    ds_add_u32 v2, v3 offset:348
    s_mov_b64 exec, -1
    s_cbranch_vccnz L_chk3
L_ret3:
    s_setprio 3
    v_smfmac_f32_32x32x32_bf16 v[64:79], v[100:103], v[40:47], v126
    ds_read_b128 v[80:83], v127 offset:0
    ds_read_b64 v[84:85], v128 offset:1024
    v_exp_f32 v16, v16
    v_exp_f32 v17, v17
    v_exp_f32 v18, v18
    v_mfma_f32_32x32x16_bf16 v[32:47], v[88:91], v[120:123], 0
    v_exp_f32 v19, v19
    v_exp_f32 v20, v20
    v_exp_f32 v21, v21
    v_exp_f32 v22, v22
    v_mfma_f32_32x32x8bf16_1k v[32:47], v[92:93], v[124:125], v[32:47]
    v_exp_f32 v23, v23
    v_exp_f32 v24, v24
    v_exp_f32 v25, v25
    v_exp_f32 v26, v26
    v_smfmac_f32_32x32x32_bf16 v[48:63], v[104:107], v[16:23], v126
    v_exp_f32 v27, v27
    v_exp_f32 v28, v28
    v_exp_f32 v29, v29
    v_exp_f32 v30, v30
    v_exp_f32 v31, v31
    ds_read_b128 v[96:99], v129 offset:1280
    ds_read_b128 v[100:103], v129 offset:1984
    v_exp_f32 v32, v32
    v_smfmac_f32_32x32x32_bf16 v[48:63], v[108:111], v[24:31], v126
    v_exp_f32 v33, v33
    v_exp_f32 v34, v34
    v_exp_f32 v35, v35
    s_waitcnt lgkmcnt(2)
    v_mfma_f32_32x32x16_bf16 v[16:31], v[80:83], v[112:115], 0
    v_exp_f32 v36, v36
    v_exp_f32 v37, v37
    v_exp_f32 v38, v38
    v_exp_f32 v39, v39
    v_mfma_f32_32x32x8bf16_1k v[16:31], v[84:85], v[116:117], v[16:31]
    v_exp_f32 v40, v40
    v_exp_f32 v41, v41
    v_exp_f32 v42, v42
    v_exp_f32 v43, v43
    v_smfmac_f32_32x32x32_bf16 v[64:79], v[104:107], v[32:39], v126
    v_exp_f32 v44, v44
    v_exp_f32 v45, v45
    v_exp_f32 v46, v46
    v_exp_f32 v47, v47
    s_waitcnt lgkmcnt(0)
    v_add_u32 v155, 16, v155
    s_add_u32 s83, s83, 1
    s_cmp_lg_u32 s83, 4
    s_cbranch_scc1 L_attn
    v_smfmac_f32_32x32x32_bf16 v[64:79], v[108:111], v[40:47], v126
    s_setprio 0
    s_branch L_epi
L_chk0:
    s_mov_b32 s82, 400000
L_g_18:
    ds_read_b32 v131, v155 offset:4
    s_waitcnt lgkmcnt(0)
    v_readfirstlane_b32 s15, v131
    s_cmp_lg_u32 s15, -1
    s_cbranch_scc1 L_gd_19
    s_sub_u32 s82, s82, 1
    s_cmp_lg_u32 s82, 0
    s_cbranch_scc1 L_g_18
L_gd_19:
    v_cmp_nle_f32 vcc, v131, v130
    s_cbranch_vccz L_ret0
L_dr0:
    s_lshl_b32 s83, s83, 2
    s_add_u32 s83, s83, 1
    s_branch L_drain
L_chk1:
    s_mov_b32 s82, 400000
L_g_20:
    ds_read_b32 v131, v155 offset:8
    s_waitcnt lgkmcnt(0)
    v_readfirstlane_b32 s15, v131
    s_cmp_lg_u32 s15, -1
    s_cbranch_scc1 L_gd_21
    s_sub_u32 s82, s82, 1
    s_cmp_lg_u32 s82, 0
    s_cbranch_scc1 L_g_20
L_gd_21:
    v_cmp_nle_f32 vcc, v131, v130
    s_cbranch_vccz L_ret1
L_dr1:
    s_lshl_b32 s83, s83, 2
    s_add_u32 s83, s83, 2
    s_branch L_drain
L_chk2:
    s_mov_b32 s82, 400000
L_g_22:
    ds_read_b32 v131, v155 offset:12
    s_waitcnt lgkmcnt(0)
    v_readfirstlane_b32 s15, v131
    s_cmp_lg_u32 s15, -1
    s_cbranch_scc1 L_gd_23
    s_sub_u32 s82, s82, 1
    s_cmp_lg_u32 s82, 0
    s_cbranch_scc1 L_g_22
L_gd_23:
    v_cmp_nle_f32 vcc, v131, v130
    s_cbranch_vccz L_ret2
L_dr2:
    s_lshl_b32 s83, s83, 2
    s_add_u32 s83, s83, 3
    s_branch L_drain
L_chk3:
    s_mov_b32 s82, 400000
L_g_24:
    ds_read_b32 v131, v155 offset:16
    s_waitcnt lgkmcnt(0)
    v_readfirstlane_b32 s15, v131
    s_cmp_lg_u32 s15, -1
    s_cbranch_scc1 L_gd_25
    s_sub_u32 s82, s82, 1
    s_cmp_lg_u32 s82, 0
    s_cbranch_scc1 L_g_24
L_gd_25:
    v_cmp_nle_f32 vcc, v131, v130
    s_cbranch_vccz L_ret3
L_dr3:
    s_lshl_b32 s83, s83, 2
    s_add_u32 s83, s83, 4
    s_branch L_drain
L_drain:
    v_smfmac_f32_32x32x32_bf16 v[64:79], v[100:103], v[40:47], v126
    v_exp_f32 v16, v16
    v_exp_f32 v17, v17
    v_exp_f32 v18, v18
    v_mfma_f32_32x32x16_bf16 v[32:47], v[88:91], v[120:123], 0
    v_exp_f32 v19, v19
    v_exp_f32 v20, v20
    v_exp_f32 v21, v21
    v_exp_f32 v22, v22
    v_mfma_f32_32x32x8bf16_1k v[32:47], v[92:93], v[124:125], v[32:47]
    v_exp_f32 v23, v23
    v_exp_f32 v24, v24
    v_exp_f32 v25, v25
    v_exp_f32 v26, v26
    v_smfmac_f32_32x32x32_bf16 v[48:63], v[104:107], v[16:23], v126
    v_exp_f32 v27, v27
    v_exp_f32 v28, v28
    v_exp_f32 v29, v29
    v_exp_f32 v30, v30
    v_exp_f32 v31, v31
    s_nop 1
    v_smfmac_f32_32x32x32_bf16 v[48:63], v[108:111], v[24:31], v126
    v_exp_f32 v32, v32
    v_exp_f32 v33, v33
    v_exp_f32 v34, v34
    v_exp_f32 v35, v35
    v_exp_f32 v36, v36
    v_exp_f32 v37, v37
    v_exp_f32 v38, v38
    v_exp_f32 v39, v39
    v_exp_f32 v40, v40
    v_exp_f32 v41, v41
    v_exp_f32 v42, v42
    v_exp_f32 v43, v43
    v_exp_f32 v44, v44
    v_exp_f32 v45, v45
    v_exp_f32 v46, v46
    v_exp_f32 v47, v47
    v_smfmac_f32_32x32x32_bf16 v[64:79], v[104:107], v[32:39], v126
    s_nop 0
    v_smfmac_f32_32x32x32_bf16 v[64:79], v[108:111], v[40:47], v126
    v_mov_b32 v132, 0
    v_mov_b32 v133, 0
    s_setprio 0
L_slow:
    s_mov_b32 s93, 1
    s_waitcnt lgkmcnt(0)
L_slow_grp:
    s_cmp_ge_u32 s83, 16
    s_cbranch_scc1 L_epi
    s_lshl_b32 s8, s83, 2
    s_add_u32 s8, s8, 59648
    v_mov_b32 v10, s8
    s_mov_b32 s82, 400000
L_g_26:
    ds_read_b32 v131, v10 offset:0
    s_waitcnt lgkmcnt(0)
    v_readfirstlane_b32 s15, v131
    s_cmp_lg_u32 s15, -1
    s_cbranch_scc1 L_gd_27
    s_sub_u32 s82, s82, 1
    s_cmp_lg_u32 s82, 0
    s_cbranch_scc1 L_g_26
L_gd_27:
    s_bfe_u32 s9, s83, 0x10001
    s_mul_i32 s9, s9, 35328
    s_and_b32 s8, s83, 1
    s_mul_i32 s8, s8, 10752
    s_add_u32 s9, s9, s8
    s_and_b32 s8, s83, 3
    s_lshl_b32 s8, s8, 2
    s_add_u32 s8, s8, 59728
    s_mov_b32 s92, 2
    v_mov_b32 v10, s8
    v_add_u32 v11, s9, v127
    v_add_u32 v12, s9, v128
    v_add_u32 v13, s9, v129
L_slow_tile:
    ds_read_b128 v[80:83], v11 offset:0
    ds_read_b64 v[84:85], v12 offset:1024
    ds_read_b128 v[96:99], v13 offset:1280
    ds_read_b128 v[100:103], v13 offset:1984
    s_cmp_lg_u32 s92, 1
    s_waitcnt lgkmcnt(0)
    s_cbranch_scc1 L_slow_go
    s_mov_b64 exec, 1
    ds_add_u32 v10, v3
    s_mov_b64 exec, -1
L_slow_go:
    v_mfma_f32_32x32x16_bf16 v[16:31], v[80:83], v[112:115], 0
    v_mfma_f32_32x32x8bf16_1k v[16:31], v[84:85], v[116:117], v[16:31]
    s_nop 11
    v_max3_f32 v8, v16, v17, v132
    v_max3_f32 v8, v18, v19, v8
    v_max3_f32 v8, v20, v21, v8
    v_max3_f32 v8, v22, v23, v8
    v_max3_f32 v8, v24, v25, v8
    v_max3_f32 v8, v26, v27, v8
    v_max3_f32 v8, v28, v29, v8
    v_max3_f32 v8, v30, v31, v8
    v_mov_b32 v9, v8
    s_nop 1
    v_permlane32_swap_b32 v8, v9
    v_max_f32 v8, v8, v9
    v_sub_f32 v9, v132, v8
    v_exp_f32 v9, v9
    v_mov_b32 v132, v8
    v_sub_f32 v16, v16, v8
    v_sub_f32 v17, v17, v8
    v_sub_f32 v18, v18, v8
    v_sub_f32 v19, v19, v8
    v_sub_f32 v20, v20, v8
    v_sub_f32 v21, v21, v8
    v_sub_f32 v22, v22, v8
    v_sub_f32 v23, v23, v8
    v_sub_f32 v24, v24, v8
    v_sub_f32 v25, v25, v8
    v_sub_f32 v26, v26, v8
    v_sub_f32 v27, v27, v8
    v_sub_f32 v28, v28, v8
    v_sub_f32 v29, v29, v8
    v_sub_f32 v30, v30, v8
    v_sub_f32 v31, v31, v8
    v_mul_f32 v48, v48, v9
    v_mul_f32 v49, v49, v9
    v_mul_f32 v50, v50, v9
    v_mul_f32 v51, v51, v9
    v_mul_f32 v52, v52, v9
    v_mul_f32 v53, v53, v9
    v_mul_f32 v54, v54, v9
    v_mul_f32 v55, v55, v9
    v_mul_f32 v56, v56, v9
    v_mul_f32 v57, v57, v9
    v_mul_f32 v58, v58, v9
    v_mul_f32 v59, v59, v9
    v_mul_f32 v60, v60, v9
    v_mul_f32 v61, v61, v9
    v_mul_f32 v62, v62, v9
    v_mul_f32 v63, v63, v9
    v_exp_f32 v16, v16
    v_exp_f32 v17, v17
    v_exp_f32 v18, v18
    v_exp_f32 v19, v19
    v_exp_f32 v20, v20
    v_exp_f32 v21, v21
    v_exp_f32 v22, v22
    v_exp_f32 v23, v23
    v_exp_f32 v24, v24
    v_exp_f32 v25, v25
    v_exp_f32 v26, v26
    v_exp_f32 v27, v27
    v_exp_f32 v28, v28
    v_exp_f32 v29, v29
    v_exp_f32 v30, v30
    v_exp_f32 v31, v31
    v_smfmac_f32_32x32x32_bf16 v[48:63], v[96:99], v[16:23], v126
    s_nop 0
    v_smfmac_f32_32x32x32_bf16 v[48:63], v[100:103], v[24:31], v126
    v_mfma_f32_32x32x16_bf16 v[32:47], v[80:83], v[120:123], 0
    v_mfma_f32_32x32x8bf16_1k v[32:47], v[84:85], v[124:125], v[32:47]
    s_nop 11
    v_max3_f32 v8, v32, v33, v133
    v_max3_f32 v8, v34, v35, v8
    v_max3_f32 v8, v36, v37, v8
    v_max3_f32 v8, v38, v39, v8
    v_max3_f32 v8, v40, v41, v8
    v_max3_f32 v8, v42, v43, v8
    v_max3_f32 v8, v44, v45, v8
    v_max3_f32 v8, v46, v47, v8
    v_mov_b32 v9, v8
    s_nop 1
    v_permlane32_swap_b32 v8, v9
    v_max_f32 v8, v8, v9
    v_sub_f32 v9, v133, v8
    v_exp_f32 v9, v9
    v_mov_b32 v133, v8
    v_sub_f32 v32, v32, v8
    v_sub_f32 v33, v33, v8
    v_sub_f32 v34, v34, v8
    v_sub_f32 v35, v35, v8
    v_sub_f32 v36, v36, v8
    v_sub_f32 v37, v37, v8
    v_sub_f32 v38, v38, v8
    v_sub_f32 v39, v39, v8
    v_sub_f32 v40, v40, v8
    v_sub_f32 v41, v41, v8
    v_sub_f32 v42, v42, v8
    v_sub_f32 v43, v43, v8
    v_sub_f32 v44, v44, v8
    v_sub_f32 v45, v45, v8
    v_sub_f32 v46, v46, v8
    v_sub_f32 v47, v47, v8
    v_mul_f32 v64, v64, v9
    v_mul_f32 v65, v65, v9
    v_mul_f32 v66, v66, v9
    v_mul_f32 v67, v67, v9
    v_mul_f32 v68, v68, v9
    v_mul_f32 v69, v69, v9
    v_mul_f32 v70, v70, v9
    v_mul_f32 v71, v71, v9
    v_mul_f32 v72, v72, v9
    v_mul_f32 v73, v73, v9
    v_mul_f32 v74, v74, v9
    v_mul_f32 v75, v75, v9
    v_mul_f32 v76, v76, v9
    v_mul_f32 v77, v77, v9
    v_mul_f32 v78, v78, v9
    v_mul_f32 v79, v79, v9
    v_exp_f32 v32, v32
    v_exp_f32 v33, v33
    v_exp_f32 v34, v34
    v_exp_f32 v35, v35
    v_exp_f32 v36, v36
    v_exp_f32 v37, v37
    v_exp_f32 v38, v38
    v_exp_f32 v39, v39
    v_exp_f32 v40, v40
    v_exp_f32 v41, v41
    v_exp_f32 v42, v42
    v_exp_f32 v43, v43
    v_exp_f32 v44, v44
    v_exp_f32 v45, v45
    v_exp_f32 v46, v46
    v_exp_f32 v47, v47
    v_smfmac_f32_32x32x32_bf16 v[64:79], v[96:99], v[32:39], v126
    s_nop 0
    v_smfmac_f32_32x32x32_bf16 v[64:79], v[100:103], v[40:47], v126
    v_add_u32 v11, 2688, v11
    v_add_u32 v12, 2688, v12
    v_add_u32 v13, 2688, v13
    s_sub_u32 s92, s92, 1
    s_cmp_lg_u32 s92, 0
    s_cbranch_scc1 L_slow_tile
    s_add_u32 s83, s83, 1
    s_branch L_slow_grp
L_epi:
    v_cmp_gt_u32 s[84:85], 32, v1
    s_nop 8
    v_mov_b32 v77, v133
    s_mov_b32 s82, 400000
L_w_28:
    ds_read_b32 v4, v2 offset:208
    s_waitcnt lgkmcnt(0)
    v_readfirstlane_b32 s15, v4
    s_cmp_ge_u32 s15, 1
    s_cbranch_scc1 L_wd_29
    s_sleep 1
    s_sub_u32 s82, s82, 1
    s_cmp_lg_u32 s82, 0
    s_cbranch_scc1 L_w_28
L_wd_29:
    s_sub_u32 s46, s15, 1
    s_mov_b32 s82, 400000
L_w_30:
    ds_read_b32 v4, v2 offset:348
    s_waitcnt lgkmcnt(0)
    v_readfirstlane_b32 s15, v4
    s_cmp_ge_u32 s15, 32
    s_cbranch_scc1 L_wd_31
    s_sleep 1
    s_sub_u32 s82, s82, 1
    s_cmp_lg_u32 s82, 0
    s_cbranch_scc1 L_w_30
L_wd_31:
    ds_write_b128 v144, v[64:67] offset:0
    ds_write_b128 v144, v[68:71] offset:1024
    ds_write_b128 v144, v[72:75] offset:2048
    ds_write_b128 v144, v[76:79] offset:3072
    s_waitcnt lgkmcnt(0)
    s_mov_b64 exec, 1
    ds_write_b32 v146, v3
    s_mov_b64 exec, -1
    s_mov_b32 s82, 400000
L_w_32:
    ds_read_b32 v4, v147 offset:0
    s_waitcnt lgkmcnt(0)
    v_readfirstlane_b32 s15, v4
    s_cmp_ge_u32 s15, 1
    s_cbranch_scc1 L_wd_33
    s_sleep 1
    s_sub_u32 s82, s82, 1
    s_cmp_lg_u32 s82, 0
    s_cbranch_scc1 L_w_32
L_wd_33:
    ds_read_b128 v[16:19], v145 offset:0
    ds_read_b128 v[20:23], v145 offset:1024
    ds_read_b128 v[24:27], v145 offset:2048
    ds_read_b128 v[28:31], v145 offset:3072
    s_waitcnt lgkmcnt(0)
    s_mov_b64 exec, 1
    ds_add_u32 v2, v3 offset:228
    s_mov_b64 exec, -1
    s_cmp_eq_u32 s93, 0
    s_cbranch_scc1 L_e_fast
    v_max_f32 v14, v132, v29
    v_sub_f32 v15, v132, v14
    v_sub_f32 v14, v29, v14
    v_exp_f32 v15, v15
    v_exp_f32 v14, v14
    s_nop 0
    v_mul_f32 v48, v48, v15
    v_mul_f32 v16, v16, v14
    v_mul_f32 v49, v49, v15
    v_mul_f32 v17, v17, v14
    v_mul_f32 v50, v50, v15
    v_mul_f32 v18, v18, v14
    v_mul_f32 v51, v51, v15
    v_mul_f32 v19, v19, v14
    v_mul_f32 v52, v52, v15
    v_mul_f32 v20, v20, v14
    v_mul_f32 v53, v53, v15
    v_mul_f32 v21, v21, v14
    v_mul_f32 v54, v54, v15
    v_mul_f32 v22, v22, v14
    v_mul_f32 v55, v55, v15
    v_mul_f32 v23, v23, v14
    v_mul_f32 v56, v56, v15
    v_mul_f32 v24, v24, v14
    v_mul_f32 v57, v57, v15
    v_mul_f32 v25, v25, v14
    v_mul_f32 v58, v58, v15
    v_mul_f32 v26, v26, v14
    v_mul_f32 v59, v59, v15
    v_mul_f32 v27, v27, v14
    v_mul_f32 v60, v60, v15
    v_mul_f32 v28, v28, v14
L_e_fast:
    v_add_f32 v56, v56, v24
    v_add_f32 v60, v60, v28
    v_add_f32 v57, v57, v25
    v_cndmask_b32 v14, v56, v60, s[84:85]
    v_rcp_f32 v14, v14
    v_pk_add_f32 v[48:49], v[48:49], v[16:17]
    v_pk_add_f32 v[50:51], v[50:51], v[18:19]
    v_pk_add_f32 v[52:53], v[52:53], v[20:21]
    v_pk_add_f32 v[54:55], v[54:55], v[22:23]
    v_pk_add_f32 v[58:59], v[58:59], v[26:27]
    v_pk_mul_f32 v[48:49], v[48:49], v[14:15] op_sel:[0,0] op_sel_hi:[1,0]
    v_pk_mul_f32 v[50:51], v[50:51], v[14:15] op_sel:[0,0] op_sel_hi:[1,0]
    v_pk_mul_f32 v[52:53], v[52:53], v[14:15] op_sel:[0,0] op_sel_hi:[1,0]
    v_pk_mul_f32 v[54:55], v[54:55], v[14:15] op_sel:[0,0] op_sel_hi:[1,0]
    v_pk_mul_f32 v[56:57], v[56:57], v[14:15] op_sel:[0,0] op_sel_hi:[1,0]
    v_pk_mul_f32 v[58:59], v[58:59], v[14:15] op_sel:[0,0] op_sel_hi:[1,0]
    v_cvt_pk_bf16_f32 v16, v48, v49
    v_cvt_pk_bf16_f32 v17, v50, v51
    v_cvt_pk_bf16_f32 v18, v52, v53
    v_cvt_pk_bf16_f32 v19, v54, v55
    v_cvt_pk_bf16_f32 v20, v56, v57
    v_cvt_pk_bf16_f32 v21, v58, v59
    s_cmp_eq_u32 s46, 0
    s_cbranch_scc1 L_tg_34
    buffer_store_dwordx4 v[16:19], v148, s[48:51], s64 offen
    s_mov_b64 exec, s[84:85]
    buffer_store_dwordx2 v[20:21], v149, s[48:51], s65 offen
    s_mov_b64 exec, -1
    s_branch L_td_35
L_tg_34:
    buffer_store_dwordx4 v[16:19], v148, s[48:51], s64 offen sc1
    s_mov_b64 exec, s[84:85]
    buffer_store_dwordx2 v[20:21], v149, s[48:51], s65 offen sc1
    s_mov_b64 exec, -1
L_td_35:
    s_cmp_eq_u32 s46, 0
    s_cselect_b32 s14, 7, 2
    s_mov_b32 s13, 172032
    s_cselect_b32 s13, s13, 462848
    s_lshl_b32 s66, s66, s14
    s_add_u32 s66, s66, s13
    v_bfe_u32 v4, v1, 5, 1
    v_lshlrev_b32 v4, 4, v4
    v_bfe_u32 v5, v1, 4, 1
    v_lshl_add_u32 v4, v5, 2, v4
    v_bfe_u32 v5, v1, 2, 2
    v_add_u32 v4, v4, v5
    v_mul_u32_u24 v4, 160, v4
    v_and_b32 v5, 3, v1
    v_lshl_add_u32 v162, v5, 3, v4
    s_cmp_eq_u32 s77, 0
    s_mov_b32 s8, 82944
    s_cselect_b32 s8, s8, 138240
    v_add_u32 v134, s8, v162
    s_mov_b32 s8, 88064
    s_cselect_b32 s8, s8, 143360
    v_add_u32 v135, s8, v162
    s_mov_b32 s8, 93184
    s_cselect_b32 s8, s8, 148480
    v_add_u32 v136, s8, v162
    s_mov_b32 s8, 98304
    s_cselect_b32 s8, s8, 153600
    v_add_u32 v137, s8, v162
    s_mov_b32 s8, 103424
    s_cselect_b32 s8, s8, 158720
    v_add_u32 v138, s8, v162
    s_mov_b32 s8, 122880
    s_cselect_b32 s8, s8, 47616
    v_add_u32 v139, s8, v162
    s_mov_b32 s8, 128000
    s_cselect_b32 s8, s8, 52736
    v_add_u32 v140, s8, v162
    s_mov_b32 s8, 133120
    s_cselect_b32 s8, s8, 36352
    v_add_u32 v141, s8, v162
    s_mov_b32 s8, 26112
    s_cselect_b32 s8, s8, 41472
    v_add_u32 v142, s8, v162
    s_mov_b32 s8, 31232
    s_cselect_b32 s8, s8, 61440
    v_add_u32 v143, s8, v162
    v_and_b32 v5, 15, v1
    s_lshl_b32 s9, s4, 1
    s_lshr_b32 s10, s76, 1
    s_add_u32 s9, s9, s10
    s_lshl_b32 s9, s9, 1
    s_add_u32 s9, s9, s77
    s_lshl_b32 s67, s9, 4
    s_cmp_eq_u32 s46, 0
    s_cselect_b32 s14, 7, 2
    s_mov_b32 s13, 172032
    s_cselect_b32 s13, s13, 462848
    s_lshl_b32 s67, s67, s14
    s_add_u32 s67, s67, s13
    v_lshlrev_b32 v150, s14, v5
    s_lshl_b32 s10, s4, 2
    s_add_u32 s10, s10, s76
    s_mul_i32 s10, s10, 20480
    s_mul_i32 s11, s77, 10240
    s_add_u32 s10, s10, s11
    s_add_u32 s68, s10, 7340032
    v_lshlrev_b32 v151, 4, v1
    s_lshl_b32 s8, s4, 6
    s_lshl_b32 s9, s76, 4
    s_add_u32 s8, s8, s9
    s_mul_i32 s8, s8, 2560
    s_mul_i32 s9, s5, 160
    s_add_u32 s69, s8, s9
    v_mul_u32_u24 v5, 2560, v5
    v_lshrrev_b32 v4, 4, v1
    v_lshl_add_u32 v152, v4, 3, v5
    v_add_u32 v153, 32, v146
    v_add_u32 v154, 32, v147
    s_lshl_b32 s8, s77, 2
    s_add_u32 s8, s8, 59624
    v_mov_b32 v156, s8
    s_mul_i32 s8, s76, 2048
    s_add_u32 s8, s8, 82944
    s_mul_i32 s9, s76, 3072
    s_add_u32 s9, s9, 138240
    s_cmp_eq_u32 s77, 0
    s_cselect_b32 s10, s8, s9
    s_cselect_b32 s11, s9, s8
    v_lshl_add_u32 v145, v1, 4, s10
    v_lshl_add_u32 v144, v1, 4, s11
    v_mov_b32 v14, s7
    s_waitcnt vmcnt(0)
    s_cmp_eq_u32 s46, 0
    s_cbranch_scc1 L_tg_36
    s_mov_b64 exec, 1
    buffer_store_dword v14, off, s[48:51], s66
    s_mov_b64 exec, -1
    s_branch L_td_37
L_tg_36:
    s_mov_b64 exec, 1
    buffer_store_dword v14, off, s[48:51], s66 sc1
    s_mov_b64 exec, -1
L_td_37:
    s_mov_b32 s82, 400000
L_w_38:
    ds_read_b32 v4, v2 offset:224
    s_waitcnt lgkmcnt(0)
    v_readfirstlane_b32 s15, v4
    s_cmp_ge_u32 s15, 1
    s_cbranch_scc1 L_wd_39
    s_sleep 1
    s_sub_u32 s82, s82, 1
    s_cmp_lg_u32 s82, 0
    s_cbranch_scc1 L_w_38
L_wd_39:
    ds_read_b64_tr_b16 v[80:81], v134 offset:0
    ds_read_b64_tr_b16 v[82:83], v134 offset:1280
    ds_read_b64_tr_b16 v[84:85], v134 offset:32
    ds_read_b64_tr_b16 v[86:87], v134 offset:1312
    ds_read_b64_tr_b16 v[88:89], v134 offset:64
    ds_read_b64_tr_b16 v[90:91], v134 offset:1344
    ds_read_b64_tr_b16 v[92:93], v134 offset:96
    ds_read_b64_tr_b16 v[94:95], v134 offset:1376
    ds_read_b64_tr_b16 v[96:97], v134 offset:128
    ds_read_b64_tr_b16 v[98:99], v134 offset:1408
    ds_read_b64_tr_b16 v[100:101], v135 offset:0
    ds_read_b64_tr_b16 v[102:103], v135 offset:1280
    ds_read_b64_tr_b16 v[104:105], v135 offset:32
    ds_read_b64_tr_b16 v[106:107], v135 offset:1312
    ds_read_b64_tr_b16 v[108:109], v135 offset:64
    ds_read_b64_tr_b16 v[110:111], v135 offset:1344
    ds_read_b64_tr_b16 v[112:113], v135 offset:96
    ds_read_b64_tr_b16 v[114:115], v135 offset:1376
    ds_read_b64_tr_b16 v[116:117], v135 offset:128
    ds_read_b64_tr_b16 v[118:119], v135 offset:1408
    s_setprio 3
    s_mov_b32 s82, 400000
L_p_40:
    buffer_load_dword v14, v150, s[48:51], s67 offen sc1
    s_waitcnt vmcnt(0)
    v_cmp_ne_u32 vcc, s7, v14
    s_cbranch_vccz L_pd_41
    s_sub_u32 s82, s82, 1
    s_cmp_lg_u32 s82, 0
    s_cbranch_scc1 L_p_40
L_pd_41:
    buffer_load_dwordx4 v[16:19], v151, s[48:51], s68 offen offset:0 sc1
    buffer_load_dwordx4 v[20:23], v151, s[48:51], s68 offen offset:1024 sc1
    buffer_load_dwordx4 v[24:27], v151, s[48:51], s68 offen offset:2048 sc1
    buffer_load_dwordx4 v[28:31], v151, s[48:51], s68 offen offset:3072 sc1
    s_add_u32 s68, s68, 4096
    buffer_load_dwordx4 v[32:35], v151, s[48:51], s68 offen offset:0 sc1
    buffer_load_dwordx4 v[36:39], v151, s[48:51], s68 offen offset:1024 sc1
    buffer_load_dwordx4 v[40:43], v151, s[48:51], s68 offen offset:2048 sc1
    buffer_load_dwordx4 v[44:47], v151, s[48:51], s68 offen offset:3072 sc1
    s_add_u32 s68, s68, 4096
    buffer_load_dwordx4 v[48:51], v151, s[48:51], s68 offen offset:0 sc1
    buffer_load_dwordx4 v[52:55], v151, s[48:51], s68 offen offset:1024 sc1
    s_setprio 0
    s_waitcnt vmcnt(9)
    s_waitcnt lgkmcnt(15)
    v_mfma_f32_16x16x32_bf16 v[56:59], v[80:83], v[16:19], 0
    ds_read_b64_tr_b16 v[80:81], v136 offset:0
    ds_read_b64_tr_b16 v[82:83], v136 offset:1280
    s_waitcnt lgkmcnt(15)
    v_mfma_f32_16x16x32_bf16 v[60:63], v[84:87], v[16:19], 0
    ds_read_b64_tr_b16 v[84:85], v136 offset:32
    ds_read_b64_tr_b16 v[86:87], v136 offset:1312
    s_waitcnt lgkmcnt(15)
    v_mfma_f32_16x16x32_bf16 v[64:67], v[88:91], v[16:19], 0
    ds_read_b64_tr_b16 v[88:89], v136 offset:64
    ds_read_b64_tr_b16 v[90:91], v136 offset:1344
    s_waitcnt lgkmcnt(15)
    v_mfma_f32_16x16x32_bf16 v[68:71], v[92:95], v[16:19], 0
    ds_read_b64_tr_b16 v[92:93], v136 offset:96
    ds_read_b64_tr_b16 v[94:95], v136 offset:1376
    s_waitcnt lgkmcnt(15)
    v_mfma_f32_16x16x32_bf16 v[72:75], v[96:99], v[16:19], 0
    ds_read_b64_tr_b16 v[96:97], v136 offset:128
    ds_read_b64_tr_b16 v[98:99], v136 offset:1408
    s_waitcnt vmcnt(8)
    s_waitcnt lgkmcnt(15)
    v_mfma_f32_16x16x32_bf16 v[56:59], v[100:103], v[20:23], v[56:59]
    ds_read_b64_tr_b16 v[100:101], v137 offset:0
    ds_read_b64_tr_b16 v[102:103], v137 offset:1280
    s_waitcnt lgkmcnt(15)
    v_mfma_f32_16x16x32_bf16 v[60:63], v[104:107], v[20:23], v[60:63]
    ds_read_b64_tr_b16 v[104:105], v137 offset:32
    ds_read_b64_tr_b16 v[106:107], v137 offset:1312
    s_waitcnt lgkmcnt(15)
    v_mfma_f32_16x16x32_bf16 v[64:67], v[108:111], v[20:23], v[64:67]
    ds_read_b64_tr_b16 v[108:109], v137 offset:64
    ds_read_b64_tr_b16 v[110:111], v137 offset:1344
    s_waitcnt lgkmcnt(15)
    v_mfma_f32_16x16x32_bf16 v[68:71], v[112:115], v[20:23], v[68:71]
    ds_read_b64_tr_b16 v[112:113], v137 offset:96
    ds_read_b64_tr_b16 v[114:115], v137 offset:1376
    s_waitcnt lgkmcnt(15)
    v_mfma_f32_16x16x32_bf16 v[72:75], v[116:119], v[20:23], v[72:75]
    ds_read_b64_tr_b16 v[116:117], v137 offset:128
    ds_read_b64_tr_b16 v[118:119], v137 offset:1408
    s_waitcnt vmcnt(7)
    s_waitcnt lgkmcnt(15)
    v_mfma_f32_16x16x32_bf16 v[56:59], v[80:83], v[24:27], v[56:59]
    ds_read_b64_tr_b16 v[80:81], v138 offset:0
    ds_read_b64_tr_b16 v[82:83], v138 offset:1280
    s_waitcnt lgkmcnt(15)
    v_mfma_f32_16x16x32_bf16 v[60:63], v[84:87], v[24:27], v[60:63]
    ds_read_b64_tr_b16 v[84:85], v138 offset:32
    ds_read_b64_tr_b16 v[86:87], v138 offset:1312
    s_waitcnt lgkmcnt(15)
    v_mfma_f32_16x16x32_bf16 v[64:67], v[88:91], v[24:27], v[64:67]
    ds_read_b64_tr_b16 v[88:89], v138 offset:64
    ds_read_b64_tr_b16 v[90:91], v138 offset:1344
    s_waitcnt lgkmcnt(15)
    v_mfma_f32_16x16x32_bf16 v[68:71], v[92:95], v[24:27], v[68:71]
    ds_read_b64_tr_b16 v[92:93], v138 offset:96
    ds_read_b64_tr_b16 v[94:95], v138 offset:1376
    s_waitcnt lgkmcnt(15)
    v_mfma_f32_16x16x32_bf16 v[72:75], v[96:99], v[24:27], v[72:75]
    ds_read_b64_tr_b16 v[96:97], v138 offset:128
    ds_read_b64_tr_b16 v[98:99], v138 offset:1408
    s_waitcnt vmcnt(6)
    s_waitcnt lgkmcnt(15)
    v_mfma_f32_16x16x32_bf16 v[56:59], v[100:103], v[28:31], v[56:59]
    ds_read_b64_tr_b16 v[100:101], v139 offset:0
    ds_read_b64_tr_b16 v[102:103], v139 offset:1280
    s_waitcnt lgkmcnt(15)
    v_mfma_f32_16x16x32_bf16 v[60:63], v[104:107], v[28:31], v[60:63]
    ds_read_b64_tr_b16 v[104:105], v139 offset:32
    ds_read_b64_tr_b16 v[106:107], v139 offset:1312
    s_waitcnt lgkmcnt(15)
    v_mfma_f32_16x16x32_bf16 v[64:67], v[108:111], v[28:31], v[64:67]
    ds_read_b64_tr_b16 v[108:109], v139 offset:64
    ds_read_b64_tr_b16 v[110:111], v139 offset:1344
    s_waitcnt lgkmcnt(15)
    v_mfma_f32_16x16x32_bf16 v[68:71], v[112:115], v[28:31], v[68:71]
    ds_read_b64_tr_b16 v[112:113], v139 offset:96
    ds_read_b64_tr_b16 v[114:115], v139 offset:1376
    s_waitcnt lgkmcnt(15)
    v_mfma_f32_16x16x32_bf16 v[72:75], v[116:119], v[28:31], v[72:75]
    ds_read_b64_tr_b16 v[116:117], v139 offset:128
    ds_read_b64_tr_b16 v[118:119], v139 offset:1408
    s_waitcnt vmcnt(5)
    s_waitcnt lgkmcnt(15)
    v_mfma_f32_16x16x32_bf16 v[56:59], v[80:83], v[32:35], v[56:59]
    ds_read_b64_tr_b16 v[80:81], v140 offset:0
    ds_read_b64_tr_b16 v[82:83], v140 offset:1280
    s_waitcnt lgkmcnt(15)
    v_mfma_f32_16x16x32_bf16 v[60:63], v[84:87], v[32:35], v[60:63]
    ds_read_b64_tr_b16 v[84:85], v140 offset:32
    ds_read_b64_tr_b16 v[86:87], v140 offset:1312
    s_waitcnt lgkmcnt(15)
    v_mfma_f32_16x16x32_bf16 v[64:67], v[88:91], v[32:35], v[64:67]
    ds_read_b64_tr_b16 v[88:89], v140 offset:64
    ds_read_b64_tr_b16 v[90:91], v140 offset:1344
    s_waitcnt lgkmcnt(15)
    v_mfma_f32_16x16x32_bf16 v[68:71], v[92:95], v[32:35], v[68:71]
    ds_read_b64_tr_b16 v[92:93], v140 offset:96
    ds_read_b64_tr_b16 v[94:95], v140 offset:1376
    s_waitcnt lgkmcnt(15)
    v_mfma_f32_16x16x32_bf16 v[72:75], v[96:99], v[32:35], v[72:75]
    ds_read_b64_tr_b16 v[96:97], v140 offset:128
    ds_read_b64_tr_b16 v[98:99], v140 offset:1408
    s_waitcnt lgkmcnt(0)
    s_mov_b64 exec, 1
    ds_add_u32 v156, v3
    s_mov_b64 exec, -1
    s_mov_b32 s82, 400000
L_w_42:
    ds_read_b32 v4, v2 offset:128
    s_waitcnt lgkmcnt(0)
    v_readfirstlane_b32 s15, v4
    s_cmp_ge_u32 s15, 4
    s_cbranch_scc1 L_wd_43
    s_sleep 1
    s_sub_u32 s82, s82, 1
    s_cmp_lg_u32 s82, 0
    s_cbranch_scc1 L_w_42
L_wd_43:
    s_waitcnt vmcnt(4)
    s_waitcnt lgkmcnt(15)
    v_mfma_f32_16x16x32_bf16 v[56:59], v[100:103], v[36:39], v[56:59]
    ds_read_b64_tr_b16 v[100:101], v141 offset:0
    ds_read_b64_tr_b16 v[102:103], v141 offset:1280
    s_waitcnt lgkmcnt(15)
    v_mfma_f32_16x16x32_bf16 v[60:63], v[104:107], v[36:39], v[60:63]
    ds_read_b64_tr_b16 v[104:105], v141 offset:32
    ds_read_b64_tr_b16 v[106:107], v141 offset:1312
    s_waitcnt lgkmcnt(15)
    v_mfma_f32_16x16x32_bf16 v[64:67], v[108:111], v[36:39], v[64:67]
    ds_read_b64_tr_b16 v[108:109], v141 offset:64
    ds_read_b64_tr_b16 v[110:111], v141 offset:1344
    s_waitcnt lgkmcnt(15)
    v_mfma_f32_16x16x32_bf16 v[68:71], v[112:115], v[36:39], v[68:71]
    ds_read_b64_tr_b16 v[112:113], v141 offset:96
    ds_read_b64_tr_b16 v[114:115], v141 offset:1376
    s_waitcnt lgkmcnt(15)
    v_mfma_f32_16x16x32_bf16 v[72:75], v[116:119], v[36:39], v[72:75]
    ds_read_b64_tr_b16 v[116:117], v141 offset:128
    ds_read_b64_tr_b16 v[118:119], v141 offset:1408
    s_waitcnt vmcnt(3)
    s_waitcnt lgkmcnt(15)
    v_mfma_f32_16x16x32_bf16 v[56:59], v[80:83], v[40:43], v[56:59]
    ds_read_b64_tr_b16 v[80:81], v142 offset:0
    ds_read_b64_tr_b16 v[82:83], v142 offset:1280
    s_waitcnt lgkmcnt(15)
    v_mfma_f32_16x16x32_bf16 v[60:63], v[84:87], v[40:43], v[60:63]
    ds_read_b64_tr_b16 v[84:85], v142 offset:32
    ds_read_b64_tr_b16 v[86:87], v142 offset:1312
    s_waitcnt lgkmcnt(15)
    v_mfma_f32_16x16x32_bf16 v[64:67], v[88:91], v[40:43], v[64:67]
    ds_read_b64_tr_b16 v[88:89], v142 offset:64
    ds_read_b64_tr_b16 v[90:91], v142 offset:1344
    s_waitcnt lgkmcnt(15)
    v_mfma_f32_16x16x32_bf16 v[68:71], v[92:95], v[40:43], v[68:71]
    ds_read_b64_tr_b16 v[92:93], v142 offset:96
    ds_read_b64_tr_b16 v[94:95], v142 offset:1376
    s_waitcnt lgkmcnt(15)
    v_mfma_f32_16x16x32_bf16 v[72:75], v[96:99], v[40:43], v[72:75]
    ds_read_b64_tr_b16 v[96:97], v142 offset:128
    ds_read_b64_tr_b16 v[98:99], v142 offset:1408
    s_waitcnt vmcnt(2)
    s_waitcnt lgkmcnt(15)
    v_mfma_f32_16x16x32_bf16 v[56:59], v[100:103], v[44:47], v[56:59]
    ds_read_b64_tr_b16 v[100:101], v143 offset:0
    ds_read_b64_tr_b16 v[102:103], v143 offset:1280
    s_waitcnt lgkmcnt(15)
    v_mfma_f32_16x16x32_bf16 v[60:63], v[104:107], v[44:47], v[60:63]
    ds_read_b64_tr_b16 v[104:105], v143 offset:32
    ds_read_b64_tr_b16 v[106:107], v143 offset:1312
    s_waitcnt lgkmcnt(15)
    v_mfma_f32_16x16x32_bf16 v[64:67], v[108:111], v[44:47], v[64:67]
    ds_read_b64_tr_b16 v[108:109], v143 offset:64
    ds_read_b64_tr_b16 v[110:111], v143 offset:1344
    s_waitcnt lgkmcnt(15)
    v_mfma_f32_16x16x32_bf16 v[68:71], v[112:115], v[44:47], v[68:71]
    ds_read_b64_tr_b16 v[112:113], v143 offset:96
    ds_read_b64_tr_b16 v[114:115], v143 offset:1376
    s_waitcnt lgkmcnt(15)
    v_mfma_f32_16x16x32_bf16 v[72:75], v[116:119], v[44:47], v[72:75]
    ds_read_b64_tr_b16 v[116:117], v143 offset:128
    ds_read_b64_tr_b16 v[118:119], v143 offset:1408
    s_waitcnt vmcnt(1)
    s_waitcnt lgkmcnt(15)
    v_mfma_f32_16x16x32_bf16 v[56:59], v[80:83], v[48:51], v[56:59]
    s_waitcnt lgkmcnt(15)
    v_mfma_f32_16x16x32_bf16 v[60:63], v[84:87], v[48:51], v[60:63]
    s_waitcnt lgkmcnt(14)
    v_mfma_f32_16x16x32_bf16 v[64:67], v[88:91], v[48:51], v[64:67]
    s_waitcnt lgkmcnt(12)
    v_mfma_f32_16x16x32_bf16 v[68:71], v[92:95], v[48:51], v[68:71]
    s_waitcnt lgkmcnt(10)
    v_mfma_f32_16x16x32_bf16 v[72:75], v[96:99], v[48:51], v[72:75]
    s_waitcnt vmcnt(0)
    s_waitcnt lgkmcnt(8)
    v_mfma_f32_16x16x32_bf16 v[56:59], v[100:103], v[52:55], v[56:59]
    s_waitcnt lgkmcnt(6)
    v_mfma_f32_16x16x32_bf16 v[60:63], v[104:107], v[52:55], v[60:63]
    s_waitcnt lgkmcnt(4)
    v_mfma_f32_16x16x32_bf16 v[64:67], v[108:111], v[52:55], v[64:67]
    s_waitcnt lgkmcnt(2)
    v_mfma_f32_16x16x32_bf16 v[68:71], v[112:115], v[52:55], v[68:71]
    s_waitcnt lgkmcnt(0)
    v_mfma_f32_16x16x32_bf16 v[72:75], v[116:119], v[52:55], v[72:75]
    s_mov_b32 s82, 400000
L_w_44:
    ds_read_b32 v4, v156 offset:0
    s_waitcnt lgkmcnt(0)
    v_readfirstlane_b32 s15, v4
    s_cmp_ge_u32 s15, 4
    s_cbranch_scc1 L_wd_45
    s_sleep 1
    s_sub_u32 s82, s82, 1
    s_cmp_lg_u32 s82, 0
    s_cbranch_scc1 L_w_44
L_wd_45:
    s_cmp_eq_u32 s77, 0
    s_cbranch_scc0 L_e_r1
    ds_write_b128 v145, v[68:71] offset:0
    ds_write_b128 v145, v[72:75] offset:1024
    s_waitcnt lgkmcnt(0)
    s_mov_b64 exec, 1
    ds_write_b32 v153, v3
    s_mov_b64 exec, -1
    s_mov_b32 s82, 400000
L_w_46:
    ds_read_b32 v4, v154 offset:0
    s_waitcnt lgkmcnt(0)
    v_readfirstlane_b32 s15, v4
    s_cmp_ge_u32 s15, 1
    s_cbranch_scc1 L_wd_47
    s_sleep 1
    s_sub_u32 s82, s82, 1
    s_cmp_lg_u32 s82, 0
    s_cbranch_scc1 L_w_46
L_wd_47:
    ds_read_b128 v[80:83], v144 offset:0
    ds_read_b128 v[84:87], v144 offset:1024
    ds_read_b128 v[88:91], v144 offset:2048
    s_waitcnt lgkmcnt(2)
    v_pk_add_f32 v[56:57], v[56:57], v[80:81]
    v_pk_add_f32 v[58:59], v[58:59], v[82:83]
    v_cvt_pk_bf16_f32 v80, v56, v57
    v_cvt_pk_bf16_f32 v81, v58, v59
    buffer_store_dwordx2 v[80:81], v152, s[60:63], s69 offen offset:0
    s_waitcnt lgkmcnt(1)
    v_pk_add_f32 v[60:61], v[60:61], v[84:85]
    v_pk_add_f32 v[62:63], v[62:63], v[86:87]
    v_cvt_pk_bf16_f32 v84, v60, v61
    v_cvt_pk_bf16_f32 v85, v62, v63
    buffer_store_dwordx2 v[84:85], v152, s[60:63], s69 offen offset:32
    s_waitcnt lgkmcnt(0)
    v_pk_add_f32 v[64:65], v[64:65], v[88:89]
    v_pk_add_f32 v[66:67], v[66:67], v[90:91]
    v_cvt_pk_bf16_f32 v88, v64, v65
    v_cvt_pk_bf16_f32 v89, v66, v67
    buffer_store_dwordx2 v[88:89], v152, s[60:63], s69 offen offset:64
    s_endpgm
L_e_r1:
    ds_write_b128 v145, v[56:59] offset:0
    ds_write_b128 v145, v[60:63] offset:1024
    ds_write_b128 v145, v[64:67] offset:2048
    s_waitcnt lgkmcnt(0)
    s_mov_b64 exec, 1
    ds_write_b32 v153, v3
    s_mov_b64 exec, -1
    s_mov_b32 s82, 400000
L_w_48:
    ds_read_b32 v4, v154 offset:0
    s_waitcnt lgkmcnt(0)
    v_readfirstlane_b32 s15, v4
    s_cmp_ge_u32 s15, 1
    s_cbranch_scc1 L_wd_49
    s_sleep 1
    s_sub_u32 s82, s82, 1
    s_cmp_lg_u32 s82, 0
    s_cbranch_scc1 L_w_48
L_wd_49:
    ds_read_b128 v[80:83], v144 offset:0
    ds_read_b128 v[84:87], v144 offset:1024
    s_waitcnt lgkmcnt(1)
    v_pk_add_f32 v[68:69], v[68:69], v[80:81]
    v_pk_add_f32 v[70:71], v[70:71], v[82:83]
    v_cvt_pk_bf16_f32 v80, v68, v69
    v_cvt_pk_bf16_f32 v81, v70, v71
    buffer_store_dwordx2 v[80:81], v152, s[60:63], s69 offen offset:96
    s_waitcnt lgkmcnt(0)
    v_pk_add_f32 v[72:73], v[72:73], v[84:85]
    v_pk_add_f32 v[74:75], v[74:75], v[86:87]
    v_cvt_pk_bf16_f32 v84, v72, v73
    v_cvt_pk_bf16_f32 v85, v74, v75
    buffer_store_dwordx2 v[84:85], v152, s[60:63], s69 offen offset:128
    s_endpgm
L_S:
    s_setprio 2
    s_sub_u32 s81, s3, 8
    s_cmp_lt_u32 s5, 2
    s_cselect_b32 s8, 2, 0
    s_xor_b32 s81, s81, s8
    s_mul_i32 s80, s4, 20
    s_lshl_b32 s8, s5, 1
    s_mul_i32 s9, s5, 3
    s_sub_u32 s9, s9, 4
    s_cmp_lt_u32 s5, 4
    s_cselect_b32 s8, s8, s9
    s_cselect_b32 s92, 2, 3
    s_add_u32 s93, s80, s8
    s_add_u32 s80, s93, s81
    s_cmp_lt_u32 s81, s92
    s_cbranch_scc1 L_kgen
    s_cmp_eq_u32 s81, 3
    s_cbranch_scc1 L_poll_kv
    s_and_b32 s92, s5, 1
    s_lshl_b32 s8, s4, 1
    s_lshr_b32 s10, s5, 1
    s_add_u32 s8, s8, s10
    s_mul_i32 s90, s8, 2688
    s_add_u32 s90, s90, 524288
    s_and_b32 s9, s8, 7
    s_mul_i32 s91, s9, 2688
    s_mul_i32 s10, s6, 21504
    s_add_u32 s91, s91, s10
    s_add_u32 s91, s91, 720896
    s_lshl_b32 s8, s8, 2
    s_add_u32 s8, s8, s92
    s_lshl_b32 s88, s8, 7
    s_add_u32 s88, s88, 4096
    s_lshl_b32 s89, s8, 3
    s_add_u32 s89, s89, 458752
    v_and_b32 v8, 15, v1
    v_lshrrev_b32 v9, 4, v1
    v_lshrrev_b32 v10, 1, v9
    v_and_b32 v11, 1, v9
    v_lshlrev_b32 v14, 4, v1
    v_add_u32 v14, 43008, v14
    s_cmp_eq_u32 s92, 1
    s_cbranch_scc1 L_kv_av
    v_lshlrev_b32 v10, 9, v10
    v_lshl_add_u32 v10, v8, 4, v10
    v_lshl_add_u32 v92, v11, 3, v10
    v_lshlrev_b32 v93, 3, v8
    v_add_u32 v93, 1024, v93
    v_add_u32 v96, 256, v92
    v_add_u32 v97, 128, v93
    s_mov_b64 s[84:85], 0xffff
    s_mov_b64 s[86:87], 0xffff
    s_mov_b32 s93, 0x3ea52b5c
    s_branch L_kv_ad
L_kv_av:
    v_mul_u32_u24 v10, 352, v10
    v_lshl_add_u32 v10, v8, 4, v10
    v_lshl_add_u32 v10, v11, 3, v10
    v_add_u32 v92, 1280, v10
    v_add_u32 v93, 1536, v10
    v_add_u32 v96, 704, v92
    v_add_u32 v97, 704, v93
    v_cmp_gt_u32 s[84:85], 6, v8
    v_cmp_gt_u32 s[86:87], 4, v8
    v_cmp_eq_u32 vcc, 4, v8
    v_mov_b32 v13, 0x3f803f80
    s_nop 0
    v_cndmask_b32 v13, 0, v13, vcc
    s_mov_b32 s93, 1.0
L_kv_ad:
    s_waitcnt lgkmcnt(0)
    s_mov_b32 s48, s44
    s_mov_b32 s49, s45
    s_mov_b32 s50, 16777216
    s_mov_b32 s51, 0x20000
    s_load_dword s7, s[44:45], 0
    v_add_u32 v4, 0, v1
    v_mul_u32_u24 v5, 6554, v4
    v_lshrrev_b32 v5, 16, v5
    v_mul_u32_u24 v7, 10, v5
    v_sub_u32 v6, v4, v7
    v_mul_u32_u24 v5, 1280, v5
    v_lshl_add_u32 v56, v6, 4, v5
    v_add_u32 v4, 64, v1
    v_mul_u32_u24 v5, 6554, v4
    v_lshrrev_b32 v5, 16, v5
    v_mul_u32_u24 v7, 10, v5
    v_sub_u32 v6, v4, v7
    v_mul_u32_u24 v5, 1280, v5
    v_lshl_add_u32 v57, v6, 4, v5
    v_add_u32 v4, 128, v1
    v_mul_u32_u24 v5, 6554, v4
    v_lshrrev_b32 v5, 16, v5
    v_mul_u32_u24 v7, 10, v5
    v_sub_u32 v6, v4, v7
    v_mul_u32_u24 v5, 1280, v5
    v_lshl_add_u32 v58, v6, 4, v5
    v_add_u32 v4, 192, v1
    v_mul_u32_u24 v5, 6554, v4
    v_lshrrev_b32 v5, 16, v5
    v_mul_u32_u24 v7, 10, v5
    v_sub_u32 v6, v4, v7
    v_mul_u32_u24 v5, 1280, v5
    v_lshl_add_u32 v59, v6, 4, v5
    v_add_u32 v4, 256, v1
    v_mul_u32_u24 v5, 6554, v4
    v_lshrrev_b32 v5, 16, v5
    v_mul_u32_u24 v7, 10, v5
    v_sub_u32 v6, v4, v7
    v_mul_u32_u24 v5, 1280, v5
    v_lshl_add_u32 v60, v6, 4, v5
    s_mov_b32 s56, s26
    s_mov_b32 s57, s27
    s_mov_b32 s58, 2621440
    s_mov_b32 s59, 0x20000
    s_lshr_b32 s8, s2, 3
    s_mul_i32 s8, s8, 81920
    s_mul_i32 s9, s6, 160
    s_add_u32 s8, s8, s9
    s_add_u32 s9, s8, 40960
    buffer_load_dwordx4 v[16:19], v56, s[56:59], s8 offen
    buffer_load_dwordx4 v[20:23], v57, s[56:59], s8 offen
    buffer_load_dwordx4 v[24:27], v58, s[56:59], s8 offen
    buffer_load_dwordx4 v[28:31], v59, s[56:59], s8 offen
    buffer_load_dwordx4 v[32:35], v60, s[56:59], s8 offen
    buffer_load_dwordx4 v[36:39], v56, s[56:59], s9 offen
    buffer_load_dwordx4 v[40:43], v57, s[56:59], s9 offen
    buffer_load_dwordx4 v[44:47], v58, s[56:59], s9 offen
    buffer_load_dwordx4 v[48:51], v59, s[56:59], s9 offen
    buffer_load_dwordx4 v[52:55], v60, s[56:59], s9 offen
    s_getreg_b32 s8, hwreg(HW_REG_XCC_ID, 0, 4)
    s_waitcnt lgkmcnt(0)
    s_add_u32 s7, s7, 2654435769
    s_add_u32 s8, s8, 1
    s_xor_b32 s46, s7, s8
    s_setprio 0
    s_mov_b32 s82, 400000
L_w_50:
    ds_read_b32 v4, v2 offset:20
    s_waitcnt lgkmcnt(0)
    v_readfirstlane_b32 s15, v4
    s_cmp_ge_u32 s15, 2
    s_cbranch_scc1 L_wd_51
    s_sub_u32 s82, s82, 1
    s_cmp_lg_u32 s82, 0
    s_cbranch_scc1 L_w_50
L_wd_51:
    s_setprio 2
    ds_read_b128 v[60:63], v14 offset:12288
    ds_read_b128 v[64:67], v14 offset:13312
    ds_read_b128 v[68:71], v14 offset:0
    ds_read_b128 v[72:75], v14 offset:1024
    s_waitcnt lgkmcnt(0)
    v_pk_add_f32 v[60:61], v[60:61], v[68:69]
    v_pk_add_f32 v[62:63], v[62:63], v[70:71]
    v_pk_add_f32 v[64:65], v[64:65], v[72:73]
    v_pk_add_f32 v[66:67], v[66:67], v[74:75]
    v_mul_f32 v60, s93, v60
    v_mul_f32 v61, s93, v61
    v_mul_f32 v62, s93, v62
    v_mul_f32 v63, s93, v63
    v_mul_f32 v64, s93, v64
    v_mul_f32 v65, s93, v65
    v_mul_f32 v66, s93, v66
    v_mul_f32 v67, s93, v67
    v_cvt_pk_bf16_f32 v68, v60, v61
    v_cvt_pk_bf16_f32 v69, v62, v63
    v_cvt_pk_bf16_f32 v70, v64, v65
    v_cvt_pk_bf16_f32 v71, v66, v67
    s_cmp_eq_u32 s92, 0
    s_cbranch_scc1 L_kk_52
    v_cndmask_b32 v70, v13, v70, s[86:87]
    v_cndmask_b32 v71, v13, v71, s[86:87]
L_kk_52:
    buffer_store_dwordx2 v[68:69], v92, s[48:51], s91 offen
    s_mov_b64 exec, s[84:85]
    buffer_store_dwordx2 v[70:71], v93, s[48:51], s91 offen
    s_mov_b64 exec, -1
    s_cmp_eq_u32 s92, 1
    s_cbranch_scc1 L_kv_55
    v_mul_f32 v12, v60, v60
    v_fmac_f32 v12, v61, v61
    v_fmac_f32 v12, v62, v62
    v_fmac_f32 v12, v63, v63
    s_mov_b64 exec, s[86:87]
    v_fmac_f32 v12, v64, v64
    v_fmac_f32 v12, v65, v65
    v_fmac_f32 v12, v66, v66
    v_fmac_f32 v12, v67, v67
    s_mov_b64 exec, -1
    v_mov_b32 v15, v12
    s_nop 1
    v_permlane16_swap_b32 v12, v15
    v_add_f32 v12, v12, v15
    v_mov_b32 v15, v12
    s_nop 1
    v_permlane32_swap_b32 v12, v15
    v_add_f32 v12, v12, v15
    s_branch L_kb_56
L_kv_55:
    v_max3_f32 v12, |v60|, |v61|, |v62|
    v_and_b32 v15, 0x7fffffff, v63
    v_max_u32 v12, v12, v15
    v_cmp_u_f32 vcc, v60, v61
    v_cmp_u_f32 s[8:9], v62, v62
    s_or_b64 vcc, vcc, s[8:9]
    v_mov_b32 v15, 0x7fc00000
    v_cndmask_b32 v12, v12, v15, vcc
    s_mov_b64 exec, s[86:87]
    v_and_b32 v15, 0x7fffffff, v64
    v_max_u32 v12, v12, v15
    v_and_b32 v15, 0x7fffffff, v65
    v_max_u32 v12, v12, v15
    v_and_b32 v15, 0x7fffffff, v66
    v_max_u32 v12, v12, v15
    v_and_b32 v15, 0x7fffffff, v67
    v_max_u32 v12, v12, v15
    s_mov_b64 exec, -1
    v_mov_b32 v15, v12
    s_nop 1
    v_permlane16_swap_b32 v12, v15
    v_max_u32 v12, v12, v15
    v_mov_b32 v15, v12
    s_nop 1
    v_permlane32_swap_b32 v12, v15
    v_max_u32 v12, v12, v15
L_kb_56:
    s_nop 1
    v_max_u32_dpp v12, v12, v12 row_ror:8 row_mask:0xf bank_mask:0xf
    s_nop 1
    v_max_u32_dpp v12, v12, v12 row_ror:4 row_mask:0xf bank_mask:0xf
    s_nop 1
    v_max_u32_dpp v12, v12, v12 row_ror:2 row_mask:0xf bank_mask:0xf
    s_nop 1
    v_max_u32_dpp v12, v12, v12 row_ror:1 row_mask:0xf bank_mask:0xf
    v_mov_b32 v101, v12
    v_mov_b32 v100, s7
    s_setprio 0
    s_mov_b32 s82, 400000
L_w_57:
    ds_read_b32 v4, v2 offset:24
    s_waitcnt lgkmcnt(0)
    v_readfirstlane_b32 s15, v4
    s_cmp_ge_u32 s15, 2
    s_cbranch_scc1 L_wd_58
    s_sub_u32 s82, s82, 1
    s_cmp_lg_u32 s82, 0
    s_cbranch_scc1 L_w_57
L_wd_58:
    s_setprio 2
    ds_read_b128 v[76:79], v14 offset:14336
    ds_read_b128 v[80:83], v14 offset:15360
    ds_read_b128 v[84:87], v14 offset:2048
    ds_read_b128 v[88:91], v14 offset:3072
    s_waitcnt lgkmcnt(0)
    v_pk_add_f32 v[76:77], v[76:77], v[84:85]
    v_pk_add_f32 v[78:79], v[78:79], v[86:87]
    v_pk_add_f32 v[80:81], v[80:81], v[88:89]
    v_pk_add_f32 v[82:83], v[82:83], v[90:91]
    v_mul_f32 v76, s93, v76
    v_mul_f32 v77, s93, v77
    v_mul_f32 v78, s93, v78
    v_mul_f32 v79, s93, v79
    v_mul_f32 v80, s93, v80
    v_mul_f32 v81, s93, v81
    v_mul_f32 v82, s93, v82
    v_mul_f32 v83, s93, v83
    v_cvt_pk_bf16_f32 v84, v76, v77
    v_cvt_pk_bf16_f32 v85, v78, v79
    v_cvt_pk_bf16_f32 v86, v80, v81
    v_cvt_pk_bf16_f32 v87, v82, v83
    s_cmp_eq_u32 s92, 0
    s_cbranch_scc1 L_kk_59
    v_cndmask_b32 v86, v13, v86, s[86:87]
    v_cndmask_b32 v87, v13, v87, s[86:87]
L_kk_59:
    buffer_store_dwordx2 v[84:85], v96, s[48:51], s91 offen
    s_mov_b64 exec, s[84:85]
    buffer_store_dwordx2 v[86:87], v97, s[48:51], s91 offen
    s_mov_b64 exec, -1
    s_cmp_eq_u32 s92, 1
    s_cbranch_scc1 L_kv_62
    v_mul_f32 v12, v76, v76
    v_fmac_f32 v12, v77, v77
    v_fmac_f32 v12, v78, v78
    v_fmac_f32 v12, v79, v79
    s_mov_b64 exec, s[86:87]
    v_fmac_f32 v12, v80, v80
    v_fmac_f32 v12, v81, v81
    v_fmac_f32 v12, v82, v82
    v_fmac_f32 v12, v83, v83
    s_mov_b64 exec, -1
    v_mov_b32 v15, v12
    s_nop 1
    v_permlane16_swap_b32 v12, v15
    v_add_f32 v12, v12, v15
    v_mov_b32 v15, v12
    s_nop 1
    v_permlane32_swap_b32 v12, v15
    v_add_f32 v12, v12, v15
    s_branch L_kb_63
L_kv_62:
    v_max3_f32 v12, |v76|, |v77|, |v78|
    v_and_b32 v15, 0x7fffffff, v79
    v_max_u32 v12, v12, v15
    v_cmp_u_f32 vcc, v76, v77
    v_cmp_u_f32 s[8:9], v78, v78
    s_or_b64 vcc, vcc, s[8:9]
    v_mov_b32 v15, 0x7fc00000
    v_cndmask_b32 v12, v12, v15, vcc
    s_mov_b64 exec, s[86:87]
    v_and_b32 v15, 0x7fffffff, v80
    v_max_u32 v12, v12, v15
    v_and_b32 v15, 0x7fffffff, v81
    v_max_u32 v12, v12, v15
    v_and_b32 v15, 0x7fffffff, v82
    v_max_u32 v12, v12, v15
    v_and_b32 v15, 0x7fffffff, v83
    v_max_u32 v12, v12, v15
    s_mov_b64 exec, -1
    v_mov_b32 v15, v12
    s_nop 1
    v_permlane16_swap_b32 v12, v15
    v_max_u32 v12, v12, v15
    v_mov_b32 v15, v12
    s_nop 1
    v_permlane32_swap_b32 v12, v15
    v_max_u32 v12, v12, v15
L_kb_63:
    s_nop 1
    v_max_u32_dpp v12, v12, v12 row_ror:8 row_mask:0xf bank_mask:0xf
    s_nop 1
    v_max_u32_dpp v12, v12, v12 row_ror:4 row_mask:0xf bank_mask:0xf
    s_nop 1
    v_max_u32_dpp v12, v12, v12 row_ror:2 row_mask:0xf bank_mask:0xf
    s_nop 1
    v_max_u32_dpp v12, v12, v12 row_ror:1 row_mask:0xf bank_mask:0xf
    v_mov_b32 v103, v12
    v_mov_b32 v102, s7
    buffer_store_dwordx2 v[68:69], v92, s[48:51], s90 offen sc1
    s_mov_b64 exec, s[84:85]
    buffer_store_dwordx2 v[70:71], v93, s[48:51], s90 offen sc1
    s_mov_b64 exec, -1
    buffer_store_dwordx2 v[84:85], v96, s[48:51], s90 offen sc1
    s_mov_b64 exec, s[84:85]
    buffer_store_dwordx2 v[86:87], v97, s[48:51], s90 offen sc1
    s_mov_b64 exec, -1
    v_mov_b32 v104, s46
    v_mov_b32 v105, v101
    v_mov_b32 v106, s46
    v_mov_b32 v107, v103
    s_waitcnt vmcnt(4)
    s_mov_b64 exec, 1
    buffer_store_dwordx2 v[104:105], off, s[48:51], s89
    buffer_store_dwordx2 v[106:107], off, s[48:51], s89 offset:16
    s_mov_b64 exec, -1
    v_lshlrev_b32 v9, 4, v1
    v_add_u32 v9, 26112, v9
    v_lshrrev_b32 v4, 4, v1
    v_bfe_u32 v5, v1, 2, 2
    v_lshl_add_u32 v5, v4, 3, v5
    v_mul_u32_u24 v5, 160, v5
    v_and_b32 v6, 3, v1
    v_lshl_add_u32 v5, v6, 3, v5
    v_add_u32 v10, 26112, v5
    v_and_b32 v5, 15, v1
    v_lshlrev_b32 v5, 12, v5
    v_lshl_add_u32 v11, v4, 4, v5
    s_mul_i32 s8, s6, 327680
    s_lshr_b32 s9, s2, 3
    s_lshl_b32 s9, s9, 7
    s_add_u32 s8, s8, s9
    s_add_u32 s11, s8, 1048576
    s_lshl_b32 s12, s2, 7
    s_add_u32 s12, s12, 36864
    ds_write_b128 v9, v[16:19] offset:0
    ds_write_b128 v9, v[20:23] offset:1024
    ds_write_b128 v9, v[24:27] offset:2048
    ds_write_b128 v9, v[28:31] offset:3072
    ds_write_b128 v9, v[32:35] offset:4096
    ds_write_b128 v9, v[36:39] offset:5120
    ds_write_b128 v9, v[40:43] offset:6144
    ds_write_b128 v9, v[44:47] offset:7168
    ds_write_b128 v9, v[48:51] offset:8192
    ds_write_b128 v9, v[52:55] offset:9216
    ds_read_b64_tr_b16 v[16:17], v10 offset:0
    ds_read_b64_tr_b16 v[18:19], v10 offset:640
    ds_read_b64_tr_b16 v[20:21], v10 offset:5120
    ds_read_b64_tr_b16 v[22:23], v10 offset:5760
    ds_read_b64_tr_b16 v[24:25], v10 offset:32
    ds_read_b64_tr_b16 v[26:27], v10 offset:672
    ds_read_b64_tr_b16 v[28:29], v10 offset:5152
    ds_read_b64_tr_b16 v[30:31], v10 offset:5792
    ds_read_b64_tr_b16 v[32:33], v10 offset:64
    ds_read_b64_tr_b16 v[34:35], v10 offset:704
    ds_read_b64_tr_b16 v[36:37], v10 offset:5184
    ds_read_b64_tr_b16 v[38:39], v10 offset:5824
    ds_read_b64_tr_b16 v[40:41], v10 offset:96
    ds_read_b64_tr_b16 v[42:43], v10 offset:736
    ds_read_b64_tr_b16 v[44:45], v10 offset:5216
    ds_read_b64_tr_b16 v[46:47], v10 offset:5856
    ds_read_b64_tr_b16 v[48:49], v10 offset:128
    ds_read_b64_tr_b16 v[50:51], v10 offset:768
    ds_read_b64_tr_b16 v[52:53], v10 offset:5248
    ds_read_b64_tr_b16 v[54:55], v10 offset:5888
    s_waitcnt lgkmcnt(0)
    s_mov_b64 exec, 1
    ds_add_u32 v2, v3 offset:212
    s_mov_b64 exec, -1
    buffer_store_dwordx4 v[16:19], v11, s[48:51], s11 offen offset:0 sc1
    buffer_store_dwordx4 v[20:23], v11, s[48:51], s11 offen offset:64 sc1
    s_add_u32 s11, s11, 65536
    buffer_store_dwordx4 v[24:27], v11, s[48:51], s11 offen offset:0 sc1
    buffer_store_dwordx4 v[28:31], v11, s[48:51], s11 offen offset:64 sc1
    s_add_u32 s11, s11, 65536
    buffer_store_dwordx4 v[32:35], v11, s[48:51], s11 offen offset:0 sc1
    buffer_store_dwordx4 v[36:39], v11, s[48:51], s11 offen offset:64 sc1
    s_add_u32 s11, s11, 65536
    buffer_store_dwordx4 v[40:43], v11, s[48:51], s11 offen offset:0 sc1
    buffer_store_dwordx4 v[44:47], v11, s[48:51], s11 offen offset:64 sc1
    s_add_u32 s11, s11, 65536
    buffer_store_dwordx4 v[48:51], v11, s[48:51], s11 offen offset:0 sc1
    buffer_store_dwordx4 v[52:55], v11, s[48:51], s11 offen offset:64 sc1
    s_add_u32 s11, s11, 65536
    s_waitcnt vmcnt(12)
    s_mov_b64 exec, 1
    buffer_store_dwordx2 v[100:101], off, s[48:51], s88 sc1
    buffer_store_dwordx2 v[102:103], off, s[48:51], s88 offset:256 sc1
    s_mov_b64 exec, -1
    v_mov_b32 v8, s7
    s_waitcnt vmcnt(2)
    s_mov_b64 exec, 1
    buffer_store_dword v8, off, s[48:51], s12 sc1
    s_mov_b64 exec, -1
    s_mov_b64 exec, 1
    ds_add_u32 v2, v3 offset:152
    s_mov_b64 exec, -1
    s_cmp_lg_u32 s2, 0
    s_cbranch_scc1 L_cv_done
    s_setprio 0
    v_lshlrev_b32 v9, 7, v1
    s_mov_b32 s82, 400000
    s_mov_b32 s8, 135168
    s_mov_b32 s9, 143360
    s_mov_b32 s10, 151552
    s_mov_b32 s11, 159744
L_zp:
    s_sleep 8
    buffer_load_dword v96, v9, s[48:51], s8 offen sc1
    buffer_load_dword v97, v9, s[48:51], s9 offen sc1
    buffer_load_dword v98, v9, s[48:51], s10 offen sc1
    buffer_load_dword v99, v9, s[48:51], s11 offen sc1
    s_waitcnt vmcnt(0)
    v_xor_b32 v10, s7, v96
    v_xor_b32 v11, s7, v97
    v_xor_b32 v12, s7, v98
    v_xor_b32 v13, s7, v99
    v_or_b32 v10, v10, v11
    v_or3_b32 v10, v10, v12, v13
    v_cmp_ne_u32 vcc, 0, v10
    s_cbranch_vccz L_zp_go
    s_sub_u32 s82, s82, 1
    s_cmp_lg_u32 s82, 0
    s_cbranch_scc1 L_zp
L_zp_go:
    v_mov_b32 v8, s7
    s_mov_b64 exec, 1
    buffer_store_dword v8, off, s[48:51], 0 sc1
    s_mov_b64 exec, -1
    s_branch L_cv_done
L_poll_kv:
    s_waitcnt lgkmcnt(0)
    s_mov_b32 s48, s44
    s_mov_b32 s49, s45
    s_mov_b32 s50, 16777216
    s_mov_b32 s51, 0x20000
    s_load_dword s7, s[44:45], 0
    s_getreg_b32 s90, hwreg(HW_REG_XCC_ID, 0, 4)
    s_lshl_b32 s8, s2, 7
    s_add_u32 s8, s8, 102400
    v_mov_b32 v11, s90
    s_waitcnt lgkmcnt(0)
    s_add_u32 s7, s7, 2654435769
    v_mov_b32 v10, s7
    s_mov_b64 exec, 1
    buffer_store_dwordx2 v[10:11], off, s[48:51], s8 sc1
    ds_write_b32 v2, v10 offset:36
    s_mov_b64 exec, -1
    v_lshlrev_b32 v117, 7, v1
    v_and_b32 v101, 31, v1
    v_lshlrev_b32 v101, 7, v101
    v_lshlrev_b32 v100, 4, v1
    s_mov_b32 s52, s24
    s_mov_b32 s53, s25
    s_mov_b32 s54, 819200
    s_mov_b32 s55, 0x20000
    s_mov_b32 s56, s18
    s_mov_b32 s57, s19
    s_mov_b32 s58, 819200
    s_mov_b32 s59, 0x20000
    v_add_u32 v4, 0, v1
    v_mul_u32_u24 v5, 6554, v4
    v_lshrrev_b32 v5, 16, v5
    v_mul_u32_u24 v7, 10, v5
    v_sub_u32 v6, v4, v7
    v_and_b32 v7, 0x13, v5
    v_bfe_u32 v4, v5, 2, 1
    v_lshl_or_b32 v7, v4, 3, v7
    v_bfe_u32 v4, v5, 3, 1
    v_lshl_or_b32 v5, v4, 2, v7
    v_mul_u32_u24 v5, 1280, v5
    v_lshl_add_u32 v16, v6, 4, v5
    v_add_u32 v4, 64, v1
    v_mul_u32_u24 v5, 6554, v4
    v_lshrrev_b32 v5, 16, v5
    v_mul_u32_u24 v7, 10, v5
    v_sub_u32 v6, v4, v7
    v_and_b32 v7, 0x13, v5
    v_bfe_u32 v4, v5, 2, 1
    v_lshl_or_b32 v7, v4, 3, v7
    v_bfe_u32 v4, v5, 3, 1
    v_lshl_or_b32 v5, v4, 2, v7
    v_mul_u32_u24 v5, 1280, v5
    v_lshl_add_u32 v17, v6, 4, v5
    v_add_u32 v4, 128, v1
    v_mul_u32_u24 v5, 6554, v4
    v_lshrrev_b32 v5, 16, v5
    v_mul_u32_u24 v7, 10, v5
    v_sub_u32 v6, v4, v7
    v_and_b32 v7, 0x13, v5
    v_bfe_u32 v4, v5, 2, 1
    v_lshl_or_b32 v7, v4, 3, v7
    v_bfe_u32 v4, v5, 3, 1
    v_lshl_or_b32 v5, v4, 2, v7
    v_mul_u32_u24 v5, 1280, v5
    v_lshl_add_u32 v18, v6, 4, v5
    v_add_u32 v4, 192, v1
    v_mul_u32_u24 v5, 6554, v4
    v_lshrrev_b32 v5, 16, v5
    v_mul_u32_u24 v7, 10, v5
    v_sub_u32 v6, v4, v7
    v_and_b32 v7, 0x13, v5
    v_bfe_u32 v4, v5, 2, 1
    v_lshl_or_b32 v7, v4, 3, v7
    v_bfe_u32 v4, v5, 3, 1
    v_lshl_or_b32 v5, v4, 2, v7
    v_mul_u32_u24 v5, 1280, v5
    v_lshl_add_u32 v19, v6, 4, v5
    v_add_u32 v4, 256, v1
    v_mul_u32_u24 v5, 6554, v4
    v_lshrrev_b32 v5, 16, v5
    v_mul_u32_u24 v7, 10, v5
    v_sub_u32 v6, v4, v7
    v_and_b32 v7, 0x13, v5
    v_bfe_u32 v4, v5, 2, 1
    v_lshl_or_b32 v7, v4, 3, v7
    v_bfe_u32 v4, v5, 3, 1
    v_lshl_or_b32 v5, v4, 2, v7
    v_mul_u32_u24 v5, 1280, v5
    v_lshl_add_u32 v20, v6, 4, v5
    s_mul_i32 s8, s4, 3
    s_add_u32 s8, s8, s5
    s_mul_i32 s9, s8, 205
    s_lshr_b32 s9, s9, 10
    s_mul_i32 s9, s9, 5
    s_sub_u32 s8, s8, s9
    s_lshl_b32 s8, s8, 1
    s_add_u32 s8, s8, 5
    s_sub_u32 s9, s8, 10
    s_cmp_ge_u32 s8, 10
    s_cselect_b32 s8, s9, s8
    s_mul_i32 s88, s5, 160
    s_mul_i32 s8, s8, 40960
    s_add_u32 s91, s8, s88
    s_add_u32 s89, s88, 409600
    s_mov_b32 s83, 0
    s_setprio 0
    s_mov_b32 s82, 400000
L_w_64:
    ds_read_b32 v4, v2 offset:220
    s_waitcnt lgkmcnt(0)
    v_readfirstlane_b32 s15, v4
    s_cmp_ge_u32 s15, 4
    s_cbranch_scc1 L_wd_65
    s_sleep 1
    s_sub_u32 s82, s82, 1
    s_cmp_lg_u32 s82, 0
    s_cbranch_scc1 L_w_64
L_wd_65:
    s_setprio 2
L_s3_wq:
    s_add_u32 m0, s83, 112640
    s_add_u32 s9, s91, 0
    buffer_load_dwordx4 v16, s[56:59], s9 offen lds
    s_add_u32 m0, m0, 1024
    s_nop 0
    buffer_load_dwordx4 v17, s[56:59], s9 offen lds
    s_add_u32 m0, m0, 1024
    s_nop 0
    buffer_load_dwordx4 v18, s[56:59], s9 offen lds
    s_add_u32 m0, m0, 1024
    s_nop 0
    buffer_load_dwordx4 v19, s[56:59], s9 offen lds
    s_add_u32 m0, m0, 1024
    s_nop 0
    buffer_load_dwordx4 v20, s[56:59], s9 offen lds
    s_add_u32 m0, s83, 138240
    s_add_u32 s9, s91, 409600
    buffer_load_dwordx4 v16, s[56:59], s9 offen lds
    s_add_u32 m0, m0, 1024
    s_nop 0
    buffer_load_dwordx4 v17, s[56:59], s9 offen lds
    s_add_u32 m0, m0, 1024
    s_nop 0
    buffer_load_dwordx4 v18, s[56:59], s9 offen lds
    s_add_u32 m0, m0, 1024
    s_nop 0
    buffer_load_dwordx4 v19, s[56:59], s9 offen lds
    s_add_u32 m0, m0, 1024
    s_nop 0
    buffer_load_dwordx4 v20, s[56:59], s9 offen lds
    s_add_u32 s91, s91, 40960
    s_cmp_eq_u32 s91, s89
    s_cselect_b32 s91, s88, s91
    s_add_u32 s83, s83, 5120
    s_cmp_lt_u32 s83, 25600
    s_cbranch_scc1 L_s3_wq
    v_add_u32 v4, 0, v1
    v_mul_u32_u24 v5, 6554, v4
    v_lshrrev_b32 v5, 16, v5
    v_mul_u32_u24 v7, 10, v5
    v_sub_u32 v6, v4, v7
    v_lshrrev_b32 v4, 4, v5
    v_lshl_add_u32 v5, v4, 2, v5
    v_mul_u32_u24 v5, 1280, v5
    v_lshl_add_u32 v106, v6, 4, v5
    v_add_u32 v4, 64, v1
    v_mul_u32_u24 v5, 6554, v4
    v_lshrrev_b32 v5, 16, v5
    v_mul_u32_u24 v7, 10, v5
    v_sub_u32 v6, v4, v7
    v_lshrrev_b32 v4, 4, v5
    v_lshl_add_u32 v5, v4, 2, v5
    v_mul_u32_u24 v5, 1280, v5
    v_lshl_add_u32 v107, v6, 4, v5
    v_add_u32 v4, 128, v1
    v_mul_u32_u24 v5, 6554, v4
    v_lshrrev_b32 v5, 16, v5
    v_mul_u32_u24 v7, 10, v5
    v_sub_u32 v6, v4, v7
    v_lshrrev_b32 v4, 4, v5
    v_lshl_add_u32 v5, v4, 2, v5
    v_mul_u32_u24 v5, 1280, v5
    v_lshl_add_u32 v108, v6, 4, v5
    v_add_u32 v4, 192, v1
    v_mul_u32_u24 v5, 6554, v4
    v_lshrrev_b32 v5, 16, v5
    v_mul_u32_u24 v7, 10, v5
    v_sub_u32 v6, v4, v7
    v_lshrrev_b32 v4, 4, v5
    v_lshl_add_u32 v5, v4, 2, v5
    v_mul_u32_u24 v5, 1280, v5
    v_lshl_add_u32 v109, v6, 4, v5
    v_add_u32 v4, 256, v1
    v_mul_u32_u24 v5, 6554, v4
    v_lshrrev_b32 v5, 16, v5
    v_mul_u32_u24 v7, 10, v5
    v_sub_u32 v6, v4, v7
    v_lshrrev_b32 v4, 4, v5
    v_lshl_add_u32 v5, v4, 2, v5
    v_mul_u32_u24 v5, 1280, v5
    v_lshl_add_u32 v110, v6, 4, v5
    s_waitcnt vmcnt(0)
    s_mov_b64 exec, 1
    ds_add_u32 v2, v3 offset:8
    s_mov_b64 exec, -1
    s_mov_b32 s72, 0
    s_mov_b32 s73, 0
    s_mov_b32 s67, 0
    s_mov_b32 s74, 82944
    s_lshl_b32 s89, s6, 12
    s_add_u32 s89, s89, 4096
    s_lshl_b32 s91, s6, 8
    s_add_u32 s91, s91, 458752
    v_and_b32 v12, 31, v1
    v_lshlrev_b32 v12, 3, v12
    s_add_u32 s8, s90, 1
    s_xor_b32 s11, s7, s8
    s_mov_b32 s82, 400000
L_pk0:
    buffer_load_dwordx2 v[14:15], v12, s[48:51], s91 offen sc1
    s_mov_b32 s46, 1
    s_waitcnt vmcnt(0)
    v_mov_b32 v13, v15
    v_cmp_ne_u32 vcc, s11, v14
    s_cbranch_vccz L_pk0_go
    s_sub_u32 s82, s82, 1
    s_and_b32 s8, s82, 3
    s_cmp_lg_u32 s8, 0
    s_cbranch_scc1 L_pk0
L_pk0_g:
    buffer_load_dwordx2 v[102:103], v101, s[48:51], s89 offen sc1
    s_mov_b32 s46, 0
    s_waitcnt vmcnt(0)
    v_mov_b32 v13, v103
    v_cmp_ne_u32 vcc, s7, v102
    s_cbranch_vccz L_pk0_go
    s_sub_u32 s82, s82, 1
    s_cmp_gt_i32 s82, 0
    s_cbranch_scc1 L_pk0
L_pk0_go:
    s_setprio 0
    s_mov_b32 s82, 400000
L_w_66:
    ds_read_b32 v4, v2 offset:212
    s_waitcnt lgkmcnt(0)
    v_readfirstlane_b32 s15, v4
    s_cmp_ge_u32 s15, 1
    s_cbranch_scc1 L_wd_67
    s_sleep 1
    s_sub_u32 s82, s82, 1
    s_cmp_lg_u32 s82, 0
    s_cbranch_scc1 L_w_66
L_wd_67:
    s_setprio 2
    s_setprio 0
    s_mov_b32 s82, 400000
L_w_68:
    ds_read_b32 v4, v2 offset:16
    s_waitcnt lgkmcnt(0)
    v_readfirstlane_b32 s15, v4
    s_cmp_ge_u32 s15, 8
    s_cbranch_scc1 L_wd_69
    s_sleep 1
    s_sub_u32 s82, s82, 1
    s_cmp_lg_u32 s82, 0
    s_cbranch_scc1 L_w_68
L_wd_69:
    s_setprio 2
L_s3_nu:
    s_setprio 3
    s_add_u32 s8, s72, s6
    s_and_b32 s8, s8, 7
    s_mul_i32 s8, s8, 21504
    s_add_u32 s8, s8, 524288
    s_and_b32 s9, s72, 1
    s_mul_i32 s9, s9, 35328
    s_add_u32 s9, s9, 26112
    s_add_u32 s72, s72, 1
    s_mul_i32 s10, s6, 21504
    s_add_u32 s10, s10, 720896
    s_cmp_eq_u32 s46, 0
    s_cselect_b32 s8, s8, s10
    s_mov_b32 m0, s9
    s_nop 0
    buffer_load_dwordx4 v100, s[48:51], s8 offen offset:0 sc1 lds
    buffer_load_dwordx4 v100, s[48:51], s8 offen offset:1024 sc1 lds
    buffer_load_dwordx4 v100, s[48:51], s8 offen offset:2048 sc1 lds
    buffer_load_dwordx4 v100, s[48:51], s8 offen offset:3072 sc1 lds
    s_add_u32 s8, s8, 4096
    s_add_u32 m0, m0, 4096
    s_nop 0
    buffer_load_dwordx4 v100, s[48:51], s8 offen offset:0 sc1 lds
    buffer_load_dwordx4 v100, s[48:51], s8 offen offset:1024 sc1 lds
    buffer_load_dwordx4 v100, s[48:51], s8 offen offset:2048 sc1 lds
    buffer_load_dwordx4 v100, s[48:51], s8 offen offset:3072 sc1 lds
    s_add_u32 s8, s8, 4096
    s_add_u32 m0, m0, 4096
    s_nop 0
    buffer_load_dwordx4 v100, s[48:51], s8 offen offset:0 sc1 lds
    buffer_load_dwordx4 v100, s[48:51], s8 offen offset:1024 sc1 lds
    buffer_load_dwordx4 v100, s[48:51], s8 offen offset:2048 sc1 lds
    buffer_load_dwordx4 v100, s[48:51], s8 offen offset:3072 sc1 lds
    s_add_u32 s8, s8, 4096
    s_add_u32 m0, m0, 4096
    s_nop 0
    buffer_load_dwordx4 v100, s[48:51], s8 offen offset:0 sc1 lds
    buffer_load_dwordx4 v100, s[48:51], s8 offen offset:1024 sc1 lds
    buffer_load_dwordx4 v100, s[48:51], s8 offen offset:2048 sc1 lds
    buffer_load_dwordx4 v100, s[48:51], s8 offen offset:3072 sc1 lds
    s_add_u32 s8, s8, 4096
    s_add_u32 m0, m0, 4096
    s_nop 0
    buffer_load_dwordx4 v100, s[48:51], s8 offen offset:0 sc1 lds
    buffer_load_dwordx4 v100, s[48:51], s8 offen offset:1024 sc1 lds
    buffer_load_dwordx4 v100, s[48:51], s8 offen offset:2048 sc1 lds
    buffer_load_dwordx4 v100, s[48:51], s8 offen offset:3072 sc1 lds
    s_add_u32 s8, s8, 4096
    s_add_u32 m0, m0, 4096
    s_nop 0
    buffer_load_dwordx4 v100, s[48:51], s8 offen offset:0 sc1 lds
    s_add_u32 s89, s6, 1
    s_and_b32 s89, s89, 7
    s_mul_i32 s91, s89, 21504
    s_add_u32 s91, s91, 524288
    s_lshl_b32 s89, s89, 12
    s_add_u32 s89, s89, 4096
    buffer_load_dwordx2 v[84:85], v101, s[48:51], s89 offen sc1
    v_mov_b32 v10, v13
    s_nop 1
    v_max_u32_dpp v10, v10, v10 row_ror:8 row_mask:0xf bank_mask:0xf
    s_nop 1
    v_max_u32_dpp v10, v10, v10 row_ror:4 row_mask:0xf bank_mask:0xf
    s_nop 1
    v_max_u32_dpp v10, v10, v10 row_ror:2 row_mask:0xf bank_mask:0xf
    v_mov_b32 v11, v10
    s_nop 1
    v_permlane16_swap_b32 v10, v11
    v_max_u32 v10, v10, v11
    v_mov_b32 v11, v10
    s_nop 1
    v_permlane32_swap_b32 v10, v11
    v_max_u32 v10, v10, v11
    s_nop 0
    v_readlane_b32 s9, v10, 1
    s_mov_b32 s10, 0x7f800000
    s_cmp_gt_u32 s9, 0x53800000
    s_cselect_b32 s10, s10, 0
    v_max_u32 v10, s10, v10
    v_mov_b32 v11, v10
    v_add_u32 v14, 256, v2
    s_waitcnt vmcnt(1)
    s_mov_b64 exec, 1
    ds_write_b64 v14, v[10:11]
    s_mov_b64 exec, -1
    s_mov_b32 s82, 400000
    s_branch L_pk1_c
L_pk1:
    buffer_load_dwordx2 v[84:85], v101, s[48:51], s89 offen sc1
L_pk1_c:
    s_waitcnt vmcnt(0)
    v_cmp_ne_u32 vcc, s7, v84
    s_cbranch_vccz L_pk1_go
    s_sub_u32 s82, s82, 1
    s_cmp_lg_u32 s82, 0
    s_cbranch_scc1 L_pk1
L_pk1_go:
    v_add_u32 v12, 0, v117
    v_min_u32 v12, 21376, v12
    buffer_load_dword v87, v12, s[48:51], s91 offen sc1
    v_add_u32 v12, 8192, v117
    v_min_u32 v12, 21376, v12
    buffer_load_dword v87, v12, s[48:51], s91 offen sc1
    v_add_u32 v12, 16384, v117
    v_min_u32 v12, 21376, v12
    buffer_load_dword v87, v12, s[48:51], s91 offen sc1
    v_mov_b32 v10, v85
    s_nop 1
    v_max_u32_dpp v10, v10, v10 row_ror:8 row_mask:0xf bank_mask:0xf
    s_nop 1
    v_max_u32_dpp v10, v10, v10 row_ror:4 row_mask:0xf bank_mask:0xf
    s_nop 1
    v_max_u32_dpp v10, v10, v10 row_ror:2 row_mask:0xf bank_mask:0xf
    v_mov_b32 v11, v10
    s_nop 1
    v_permlane16_swap_b32 v10, v11
    v_max_u32 v10, v10, v11
    v_mov_b32 v11, v10
    s_nop 1
    v_permlane32_swap_b32 v10, v11
    v_max_u32 v10, v10, v11
    s_nop 0
    v_readlane_b32 s9, v10, 1
    s_mov_b32 s10, 0x7f800000
    s_cmp_gt_u32 s9, 0x53800000
    s_cselect_b32 s10, s10, 0
    v_max_u32 v10, s10, v10
    v_mov_b32 v82, v10
    v_mov_b32 v83, v10
    s_setprio 0
    s_mov_b32 s82, 400000
L_w_70:
    ds_read_b32 v4, v2 offset:136
    s_waitcnt lgkmcnt(0)
    v_readfirstlane_b32 s15, v4
    s_cmp_ge_u32 s15, 8
    s_cbranch_scc1 L_wd_71
    s_sleep 1
    s_sub_u32 s82, s82, 1
    s_cmp_lg_u32 s82, 0
    s_cbranch_scc1 L_w_70
L_wd_71:
    s_setprio 3
    s_add_u32 s8, s72, s6
    s_and_b32 s8, s8, 7
    s_mul_i32 s8, s8, 21504
    s_add_u32 s8, s8, 524288
    s_and_b32 s9, s72, 1
    s_mul_i32 s9, s9, 35328
    s_add_u32 s9, s9, 26112
    s_add_u32 s72, s72, 1
    s_mov_b32 m0, s9
    s_nop 0
    buffer_load_dwordx4 v100, s[48:51], s8 offen offset:0 sc1 lds
    buffer_load_dwordx4 v100, s[48:51], s8 offen offset:1024 sc1 lds
    buffer_load_dwordx4 v100, s[48:51], s8 offen offset:2048 sc1 lds
    buffer_load_dwordx4 v100, s[48:51], s8 offen offset:3072 sc1 lds
    s_add_u32 s8, s8, 4096
    s_add_u32 m0, m0, 4096
    s_nop 0
    buffer_load_dwordx4 v100, s[48:51], s8 offen offset:0 sc1 lds
    buffer_load_dwordx4 v100, s[48:51], s8 offen offset:1024 sc1 lds
    buffer_load_dwordx4 v100, s[48:51], s8 offen offset:2048 sc1 lds
    buffer_load_dwordx4 v100, s[48:51], s8 offen offset:3072 sc1 lds
    s_add_u32 s8, s8, 4096
    s_add_u32 m0, m0, 4096
    s_nop 0
    buffer_load_dwordx4 v100, s[48:51], s8 offen offset:0 sc1 lds
    buffer_load_dwordx4 v100, s[48:51], s8 offen offset:1024 sc1 lds
    buffer_load_dwordx4 v100, s[48:51], s8 offen offset:2048 sc1 lds
    buffer_load_dwordx4 v100, s[48:51], s8 offen offset:3072 sc1 lds
    s_add_u32 s8, s8, 4096
    s_add_u32 m0, m0, 4096
    s_nop 0
    buffer_load_dwordx4 v100, s[48:51], s8 offen offset:0 sc1 lds
    buffer_load_dwordx4 v100, s[48:51], s8 offen offset:1024 sc1 lds
    buffer_load_dwordx4 v100, s[48:51], s8 offen offset:2048 sc1 lds
    buffer_load_dwordx4 v100, s[48:51], s8 offen offset:3072 sc1 lds
    s_add_u32 s8, s8, 4096
    s_add_u32 m0, m0, 4096
    s_nop 0
    buffer_load_dwordx4 v100, s[48:51], s8 offen offset:0 sc1 lds
    buffer_load_dwordx4 v100, s[48:51], s8 offen offset:1024 sc1 lds
    buffer_load_dwordx4 v100, s[48:51], s8 offen offset:2048 sc1 lds
    buffer_load_dwordx4 v100, s[48:51], s8 offen offset:3072 sc1 lds
    s_add_u32 s8, s8, 4096
    s_add_u32 m0, m0, 4096
    s_nop 0
    buffer_load_dwordx4 v100, s[48:51], s8 offen offset:0 sc1 lds
    s_mov_b32 s8, 4096
    s_mov_b32 s9, 12288
    s_mov_b32 s10, 20480
    s_mov_b32 s11, 28672
    buffer_load_dwordx2 v[88:89], v117, s[48:51], s8 offen sc1
    buffer_load_dwordx2 v[90:91], v117, s[48:51], s9 offen sc1
    buffer_load_dwordx2 v[92:93], v117, s[48:51], s10 offen sc1
    buffer_load_dwordx2 v[94:95], v117, s[48:51], s11 offen sc1
    v_add_u32 v14, 8, v14
    s_mov_b32 s82, 400000
    s_waitcnt vmcnt(4)
    s_mov_b64 exec, 1
    ds_write_b64 v14, v[82:83]
    s_mov_b64 exec, -1
    v_add_u32 v4, 0, v1
    v_mul_u32_u24 v5, 6554, v4
    v_lshrrev_b32 v5, 16, v5
    v_mul_u32_u24 v7, 10, v5
    v_sub_u32 v6, v4, v7
    v_lshrrev_b32 v4, 2, v5
    v_mul_u32_u24 v4, 20, v4
    v_and_b32 v5, 3, v5
    v_add3_u32 v5, v4, v5, 16
    v_mul_u32_u24 v5, 1280, v5
    v_lshl_add_u32 v112, v6, 4, v5
    v_add_u32 v4, 64, v1
    v_mul_u32_u24 v5, 6554, v4
    v_lshrrev_b32 v5, 16, v5
    v_mul_u32_u24 v7, 10, v5
    v_sub_u32 v6, v4, v7
    v_lshrrev_b32 v4, 2, v5
    v_mul_u32_u24 v4, 20, v4
    v_and_b32 v5, 3, v5
    v_add3_u32 v5, v4, v5, 16
    v_mul_u32_u24 v5, 1280, v5
    v_lshl_add_u32 v113, v6, 4, v5
    v_add_u32 v4, 128, v1
    v_mul_u32_u24 v5, 6554, v4
    v_lshrrev_b32 v5, 16, v5
    v_mul_u32_u24 v7, 10, v5
    v_sub_u32 v6, v4, v7
    v_lshrrev_b32 v4, 2, v5
    v_mul_u32_u24 v4, 20, v4
    v_and_b32 v5, 3, v5
    v_add3_u32 v5, v4, v5, 16
    v_mul_u32_u24 v5, 1280, v5
    v_lshl_add_u32 v114, v6, 4, v5
    v_add_u32 v4, 192, v1
    v_mul_u32_u24 v5, 6554, v4
    v_lshrrev_b32 v5, 16, v5
    v_mul_u32_u24 v7, 10, v5
    v_sub_u32 v6, v4, v7
    v_lshrrev_b32 v4, 2, v5
    v_mul_u32_u24 v4, 20, v4
    v_and_b32 v5, 3, v5
    v_add3_u32 v5, v4, v5, 16
    v_mul_u32_u24 v5, 1280, v5
    v_lshl_add_u32 v115, v6, 4, v5
    v_add_u32 v4, 256, v1
    v_mul_u32_u24 v5, 6554, v4
    v_lshrrev_b32 v5, 16, v5
    v_mul_u32_u24 v7, 10, v5
    v_sub_u32 v6, v4, v7
    v_lshrrev_b32 v4, 2, v5
    v_mul_u32_u24 v4, 20, v4
    v_and_b32 v5, 3, v5
    v_add3_u32 v5, v4, v5, 16
    v_mul_u32_u24 v5, 1280, v5
    v_lshl_add_u32 v116, v6, 4, v5
    s_mov_b32 s8, 4096
    s_mov_b32 s9, 12288
    s_mov_b32 s10, 20480
    s_mov_b32 s11, 28672
    s_branch L_pka_c
L_pka:
    buffer_load_dwordx2 v[88:89], v117, s[48:51], s8 offen sc1
    buffer_load_dwordx2 v[90:91], v117, s[48:51], s9 offen sc1
    buffer_load_dwordx2 v[92:93], v117, s[48:51], s10 offen sc1
    buffer_load_dwordx2 v[94:95], v117, s[48:51], s11 offen sc1
L_pka_c:
    s_waitcnt vmcnt(0)
    v_xor_b32 v10, s7, v88
    v_xor_b32 v11, s7, v90
    v_xor_b32 v12, s7, v92
    v_xor_b32 v13, s7, v94
    v_or_b32 v10, v10, v11
    v_or3_b32 v10, v10, v12, v13
    v_cmp_ne_u32 vcc, 0, v10
    s_cbranch_vccz L_pka_go
    s_sub_u32 s82, s82, 1
    s_cmp_lg_u32 s82, 0
    s_cbranch_scc1 L_pka
L_pka_go:
    v_max_u32 v89, v89, v91
    v_max3_u32 v104, v89, v93, v95
    s_lshr_b32 s8, s2, 3
    s_mul_i32 s9, s8, 5376
    s_add_u32 s9, s9, 524288
    v_min_u32 v12, 5248, v117
    buffer_load_dword v87, v12, s[48:51], s9 offen sc1
    v_mov_b32 v10, v104
    s_nop 1
    v_max_u32_dpp v10, v10, v10 row_ror:8 row_mask:0xf bank_mask:0xf
    s_nop 1
    v_max_u32_dpp v10, v10, v10 row_ror:4 row_mask:0xf bank_mask:0xf
    s_nop 1
    v_max_u32_dpp v10, v10, v10 row_ror:2 row_mask:0xf bank_mask:0xf
    v_mov_b32 v11, v10
    s_nop 1
    v_permlane16_swap_b32 v10, v11
    v_max_u32 v10, v10, v11
    v_mov_b32 v11, v10
    s_nop 1
    v_permlane32_swap_b32 v10, v11
    v_max_u32 v10, v10, v11
    s_nop 0
    v_readlane_b32 s9, v10, 1
    s_mov_b32 s10, 0x7f800000
    s_cmp_gt_u32 s9, 0x53800000
    s_cselect_b32 s10, s10, 0
    v_max_u32 v10, s10, v10
    v_mov_b32 v104, v10
    v_add_u32 v14, 4, v14
    s_mov_b32 s72, 4
    v_and_b32 v86, 31, v1
    v_lshlrev_b32 v86, 10, v86
    s_lshl_b32 s89, s6, 7
    s_add_u32 s89, s89, 102400
    buffer_load_dwordx2 v[84:85], v86, s[48:51], s89 offen sc1
L_ld:
    s_mov_b32 s82, 400000
    s_and_b32 s8, s72, 3
    s_lshl_b32 s8, s8, 2
    s_add_u32 s8, s8, 59728
    v_mov_b32 v15, s8
    s_lshr_b32 s90, s72, 2
    s_lshl_b32 s90, s90, 3
    s_lshr_b32 s8, s72, 1
    s_and_b32 s9, s8, 1
    s_add_u32 s8, s8, s6
    s_and_b32 s8, s8, 7
    s_mul_i32 s8, s8, 21504
    s_mul_i32 s9, s9, 35328
    s_and_b32 s10, s72, 1
    s_mul_i32 s10, s10, 10752
    s_add_u32 s8, s8, s10
    s_add_u32 s8, s8, 524288
    s_add_u32 s9, s9, s10
    s_add_u32 m0, s9, 26112
L_fr:
    ds_read_b32 v8, v15
    s_waitcnt lgkmcnt(0)
    v_readfirstlane_b32 s15, v8
    s_cmp_ge_u32 s15, s90
    s_cbranch_scc1 L_fr_go
    s_sleep 1
    s_sub_u32 s82, s82, 1
    s_cmp_lg_u32 s82, 0
    s_cbranch_scc1 L_fr
L_fr_go:
    buffer_load_dwordx4 v100, s[48:51], s8 offen offset:0 sc1 lds
    buffer_load_dwordx4 v100, s[48:51], s8 offen offset:1024 sc1 lds
    buffer_load_dwordx4 v100, s[48:51], s8 offen offset:2048 sc1 lds
    buffer_load_dwordx4 v100, s[48:51], s8 offen offset:3072 sc1 lds
    s_add_u32 s8, s8, 4096
    s_add_u32 m0, m0, 4096
    s_nop 0
    buffer_load_dwordx4 v100, s[48:51], s8 offen offset:0 sc1 lds
    buffer_load_dwordx4 v100, s[48:51], s8 offen offset:1024 sc1 lds
    buffer_load_dwordx4 v100, s[48:51], s8 offen offset:2048 sc1 lds
    buffer_load_dwordx4 v100, s[48:51], s8 offen offset:3072 sc1 lds
    s_add_u32 s8, s8, 4096
    s_add_u32 m0, m0, 4096
    s_nop 0
    buffer_load_dwordx4 v100, s[48:51], s8 offen offset:0 sc1 lds
    buffer_load_dwordx4 v100, s[48:51], s8 offen offset:1024 sc1 lds
    s_mov_b32 exec_hi, 0
    buffer_load_dwordx4 v100, s[48:51], s8 offen offset:2048 sc1 lds
    s_mov_b64 exec, -1
    v_add_u32 v14, 4, v14
    s_add_u32 s72, s72, 1
    s_waitcnt vmcnt(0)
    s_mov_b64 exec, 1
    ds_write_b32 v14, v104
    s_mov_b64 exec, -1
    s_cmp_eq_u32 s72, 6
    s_cbranch_scc0 L_nox
    s_mov_b32 s82, 400000
    s_getreg_b32 s11, hwreg(HW_REG_XCC_ID, 0, 4)
    s_branch L_px_c
L_px:
    buffer_load_dwordx2 v[84:85], v86, s[48:51], s89 offen sc1
    s_waitcnt vmcnt(0)
L_px_c:
    v_cmp_ne_u32 vcc, s7, v84
    s_cbranch_vccz L_px_go
    s_sub_u32 s82, s82, 1
    s_cmp_lg_u32 s82, 0
    s_cbranch_scc1 L_px
L_px_go:
    v_cmp_ne_u32 s[84:85], s11, v85
    s_or_b64 vcc, vcc, s[84:85]
    s_cmp_eq_u64 vcc, 0
    s_cselect_b32 s9, 2, 1
    v_mov_b32 v8, s9
    s_mov_b64 exec, 1
    ds_write_b32 v2, v8 offset:208
    s_mov_b64 exec, -1
    s_setprio 0
    s_mov_b32 s82, 400000
L_w_72:
    ds_read_b32 v4, v2 offset:212
    s_waitcnt lgkmcnt(0)
    v_readfirstlane_b32 s15, v4
    s_cmp_ge_u32 s15, 1
    s_cbranch_scc1 L_wd_73
    s_sleep 1
    s_sub_u32 s82, s82, 1
    s_cmp_lg_u32 s82, 0
    s_cbranch_scc1 L_w_72
L_wd_73:
    s_setprio 3
    s_lshl_b32 s9, s2, 7
    s_add_u32 s9, s9, 135168
    v_mov_b32 v8, s7
    s_mov_b64 exec, 1
    buffer_store_dword v8, off, s[48:51], s9 sc1
    s_mov_b64 exec, -1
L_nox:
    s_add_u32 s75, s67, 1
    s_cmp_ge_u32 s72, 14
    s_cselect_b32 s8, 1, 0
    s_add_u32 s75, s75, s8
    s_cmp_lt_u32 s75, 14
    s_cbranch_scc1 L_ld_u
    s_setprio 0
    s_mov_b32 s82, 400000
L_w_74:
    ds_read_b32 v4, v2 offset:212
    s_waitcnt lgkmcnt(0)
    v_readfirstlane_b32 s15, v4
    s_cmp_ge_u32 s15, 1
    s_cbranch_scc1 L_wd_75
    s_sleep 1
    s_sub_u32 s82, s82, 1
    s_cmp_lg_u32 s82, 0
    s_cbranch_scc1 L_w_74
L_wd_75:
    s_setprio 3
L_ld_u:
L_u_76:
    s_cmp_ge_u32 s67, s75
    s_cbranch_scc1 L_ud_79
    s_mul_i32 s9, s73, 52
    s_lshr_b32 s9, s9, 8
    s_mul_i32 s10, s9, 5
    s_sub_u32 s10, s73, s10
    s_mul_i32 s8, s9, 204800
    s_add_u32 s8, s8, s88
    s_mov_b32 m0, s74
    s_cmp_eq_u32 s10, 4
    s_cbranch_scc1 L_ul_77
    s_mul_i32 s10, s10, 51200
    s_add_u32 s8, s8, s10
    buffer_load_dwordx4 v106, s[52:55], s8 offen lds
    s_add_u32 m0, m0, 1024
    s_nop 0
    buffer_load_dwordx4 v107, s[52:55], s8 offen lds
    s_add_u32 m0, m0, 1024
    s_nop 0
    buffer_load_dwordx4 v108, s[52:55], s8 offen lds
    s_add_u32 m0, m0, 1024
    s_nop 0
    buffer_load_dwordx4 v109, s[52:55], s8 offen lds
    s_add_u32 m0, m0, 1024
    s_nop 0
    buffer_load_dwordx4 v110, s[52:55], s8 offen lds
    s_add_u32 m0, m0, 1024
    s_branch L_un_78
L_ul_77:
    buffer_load_dwordx4 v112, s[52:55], s8 offen lds
    s_add_u32 m0, m0, 1024
    s_nop 0
    buffer_load_dwordx4 v113, s[52:55], s8 offen lds
    s_add_u32 m0, m0, 1024
    s_nop 0
    buffer_load_dwordx4 v114, s[52:55], s8 offen lds
    s_add_u32 m0, m0, 1024
    s_nop 0
    buffer_load_dwordx4 v115, s[52:55], s8 offen lds
    s_add_u32 m0, m0, 1024
    s_nop 0
    buffer_load_dwordx4 v116, s[52:55], s8 offen lds
    s_add_u32 m0, m0, 1024
L_un_78:
    s_add_u32 s73, s73, 1
    s_add_u32 s67, s67, 1
    s_mov_b32 s74, m0
    s_cmp_eq_u32 s67, 5
    s_cselect_b32 s74, 122880, s74
    s_cselect_b32 s73, 5, s73
    s_cmp_eq_u32 s67, 8
    s_cselect_b32 s74, 138240, s74
    s_cselect_b32 s73, 10, s73
    s_cmp_eq_u32 s67, 13
    s_cselect_b32 s74, 47616, s74
    s_cselect_b32 s73, 15, s73
    s_cmp_eq_u32 s67, 15
    s_cselect_b32 s74, 26112, s74
    s_cselect_b32 s73, 8, s73
    s_cmp_eq_u32 s67, 17
    s_cselect_b32 s74, 36352, s74
    s_cselect_b32 s73, 17, s73
    s_cmp_eq_u32 s67, 19
    s_cselect_b32 s74, 61440, s74
    s_cselect_b32 s73, 19, s73
    s_branch L_u_76
L_ud_79:
    s_cmp_lt_u32 s72, 16
    s_cbranch_scc1 L_ld
    s_mov_b32 s75, 15
L_u_80:
    s_cmp_ge_u32 s67, s75
    s_cbranch_scc1 L_ud_83
    s_mul_i32 s9, s73, 52
    s_lshr_b32 s9, s9, 8
    s_mul_i32 s10, s9, 5
    s_sub_u32 s10, s73, s10
    s_mul_i32 s8, s9, 204800
    s_add_u32 s8, s8, s88
    s_mov_b32 m0, s74
    s_cmp_eq_u32 s10, 4
    s_cbranch_scc1 L_ul_81
    s_mul_i32 s10, s10, 51200
    s_add_u32 s8, s8, s10
    buffer_load_dwordx4 v106, s[52:55], s8 offen lds
    s_add_u32 m0, m0, 1024
    s_nop 0
    buffer_load_dwordx4 v107, s[52:55], s8 offen lds
    s_add_u32 m0, m0, 1024
    s_nop 0
    buffer_load_dwordx4 v108, s[52:55], s8 offen lds
    s_add_u32 m0, m0, 1024
    s_nop 0
    buffer_load_dwordx4 v109, s[52:55], s8 offen lds
    s_add_u32 m0, m0, 1024
    s_nop 0
    buffer_load_dwordx4 v110, s[52:55], s8 offen lds
    s_add_u32 m0, m0, 1024
    s_branch L_un_82
L_ul_81:
    buffer_load_dwordx4 v112, s[52:55], s8 offen lds
    s_add_u32 m0, m0, 1024
    s_nop 0
    buffer_load_dwordx4 v113, s[52:55], s8 offen lds
    s_add_u32 m0, m0, 1024
    s_nop 0
    buffer_load_dwordx4 v114, s[52:55], s8 offen lds
    s_add_u32 m0, m0, 1024
    s_nop 0
    buffer_load_dwordx4 v115, s[52:55], s8 offen lds
    s_add_u32 m0, m0, 1024
    s_nop 0
    buffer_load_dwordx4 v116, s[52:55], s8 offen lds
    s_add_u32 m0, m0, 1024
L_un_82:
    s_add_u32 s73, s73, 1
    s_add_u32 s67, s67, 1
    s_mov_b32 s74, m0
    s_cmp_eq_u32 s67, 5
    s_cselect_b32 s74, 122880, s74
    s_cselect_b32 s73, 5, s73
    s_cmp_eq_u32 s67, 8
    s_cselect_b32 s74, 138240, s74
    s_cselect_b32 s73, 10, s73
    s_cmp_eq_u32 s67, 13
    s_cselect_b32 s74, 47616, s74
    s_cselect_b32 s73, 15, s73
    s_cmp_eq_u32 s67, 15
    s_cselect_b32 s74, 26112, s74
    s_cselect_b32 s73, 8, s73
    s_cmp_eq_u32 s67, 17
    s_cselect_b32 s74, 36352, s74
    s_cselect_b32 s73, 17, s73
    s_cmp_eq_u32 s67, 19
    s_cselect_b32 s74, 61440, s74
    s_cselect_b32 s73, 19, s73
    s_branch L_u_80
L_ud_83:
L_ld_done:
    s_waitcnt vmcnt(0)
    s_mov_b64 exec, 1
    ds_add_u32 v2, v3 offset:224
    s_mov_b64 exec, -1
    s_setprio 0
    s_mov_b32 s82, 400000
L_w_84:
    ds_read_b32 v4, v2 offset:228
    s_waitcnt lgkmcnt(0)
    v_readfirstlane_b32 s15, v4
    s_cmp_ge_u32 s15, 8
    s_cbranch_scc1 L_wd_85
    s_sleep 1
    s_sub_u32 s82, s82, 1
    s_cmp_lg_u32 s82, 0
    s_cbranch_scc1 L_w_84
L_wd_85:
    s_setprio 3
    s_mov_b32 s75, 20
L_u_86:
    s_cmp_ge_u32 s67, s75
    s_cbranch_scc1 L_ud_89
    s_mul_i32 s9, s73, 52
    s_lshr_b32 s9, s9, 8
    s_mul_i32 s10, s9, 5
    s_sub_u32 s10, s73, s10
    s_mul_i32 s8, s9, 204800
    s_add_u32 s8, s8, s88
    s_mov_b32 m0, s74
    s_cmp_eq_u32 s10, 4
    s_cbranch_scc1 L_ul_87
    s_mul_i32 s10, s10, 51200
    s_add_u32 s8, s8, s10
    buffer_load_dwordx4 v106, s[52:55], s8 offen lds
    s_add_u32 m0, m0, 1024
    s_nop 0
    buffer_load_dwordx4 v107, s[52:55], s8 offen lds
    s_add_u32 m0, m0, 1024
    s_nop 0
    buffer_load_dwordx4 v108, s[52:55], s8 offen lds
    s_add_u32 m0, m0, 1024
    s_nop 0
    buffer_load_dwordx4 v109, s[52:55], s8 offen lds
    s_add_u32 m0, m0, 1024
    s_nop 0
    buffer_load_dwordx4 v110, s[52:55], s8 offen lds
    s_add_u32 m0, m0, 1024
    s_branch L_un_88
L_ul_87:
    buffer_load_dwordx4 v112, s[52:55], s8 offen lds
    s_add_u32 m0, m0, 1024
    s_nop 0
    buffer_load_dwordx4 v113, s[52:55], s8 offen lds
    s_add_u32 m0, m0, 1024
    s_nop 0
    buffer_load_dwordx4 v114, s[52:55], s8 offen lds
    s_add_u32 m0, m0, 1024
    s_nop 0
    buffer_load_dwordx4 v115, s[52:55], s8 offen lds
    s_add_u32 m0, m0, 1024
    s_nop 0
    buffer_load_dwordx4 v116, s[52:55], s8 offen lds
    s_add_u32 m0, m0, 1024
L_un_88:
    s_add_u32 s73, s73, 1
    s_add_u32 s67, s67, 1
    s_mov_b32 s74, m0
    s_cmp_eq_u32 s67, 5
    s_cselect_b32 s74, 122880, s74
    s_cselect_b32 s73, 5, s73
    s_cmp_eq_u32 s67, 8
    s_cselect_b32 s74, 138240, s74
    s_cselect_b32 s73, 10, s73
    s_cmp_eq_u32 s67, 13
    s_cselect_b32 s74, 47616, s74
    s_cselect_b32 s73, 15, s73
    s_cmp_eq_u32 s67, 15
    s_cselect_b32 s74, 26112, s74
    s_cselect_b32 s73, 8, s73
    s_cmp_eq_u32 s67, 17
    s_cselect_b32 s74, 36352, s74
    s_cselect_b32 s73, 17, s73
    s_cmp_eq_u32 s67, 19
    s_cselect_b32 s74, 61440, s74
    s_cselect_b32 s73, 19, s73
    s_branch L_u_86
L_ud_89:
    v_mov_b32 v8, 4
    s_waitcnt vmcnt(0)
    s_mov_b64 exec, 1
    ds_add_u32 v2, v8 offset:128
    s_mov_b64 exec, -1
    s_branch L_yout
L_kgen:
    s_setprio 3
    s_mul_i32 s88, s81, 8704
    v_lshlrev_b32 v8, 1, v1
    s_mul_i32 s8, s80, 384
    s_lshl_b32 s9, s80, 1
    v_and_b32 v4, 1, v1
    v_bfe_u32 v5, v1, 2, 1
    v_lshl_or_b32 v4, v5, 1, v4
    v_bfe_u32 v5, v1, 1, 1
    v_lshl_or_b32 v4, v5, 2, v4
    v_lshlrev_b32 v4, 4, v4
    v_lshl_add_u32 v4, v1, 7, v4
    v_add_u32 v156, s88, v4
    v_xor_b32 v157, 16, v156
    v_xor_b32 v158, 32, v156
    v_xor_b32 v159, 48, v156
    v_xor_b32 v160, 64, v156
    v_xor_b32 v161, 80, v156
    v_xor_b32 v162, 96, v156
    v_xor_b32 v163, 112, v156
    v_lshrrev_b32 v4, 5, v1
    v_bfe_u32 v5, v1, 2, 2
    v_lshl_add_u32 v6, v4, 2, v5
    v_and_b32 v7, 1, v5
    v_lshl_or_b32 v7, v4, 1, v7
    v_lshrrev_b32 v5, 1, v5
    v_lshl_or_b32 v7, v5, 2, v7
    v_bfe_u32 v4, v1, 4, 1
    v_bfe_u32 v5, v1, 1, 1
    v_lshl_or_b32 v4, v4, 1, v5
    v_xor_b32 v4, v4, v7
    v_lshlrev_b32 v4, 4, v4
    v_lshl_add_u32 v4, v6, 7, v4
    v_and_b32 v5, 1, v1
    v_lshl_add_u32 v4, v5, 3, v4
    v_add_u32 v31, s88, v4
    v_xor_b32 v32, 64, v31
    s_waitcnt lgkmcnt(0)
    s_mov_b32 s48, s44
    s_mov_b32 s49, s45
    s_mov_b32 s50, 16777216
    s_mov_b32 s51, 0x20000
    s_mov_b32 s68, s36
    s_mov_b32 s69, s37
    s_mov_b32 s70, 1280
    s_mov_b32 s71, 0x20000
    s_mov_b32 s52, s28
    s_mov_b32 s53, s29
    s_mov_b32 s54, 245760
    s_mov_b32 s55, 0x20000
    s_mov_b32 s56, s30
    s_mov_b32 s57, s31
    s_mov_b32 s58, 245760
    s_mov_b32 s59, 0x20000
    s_mov_b32 s60, s32
    s_mov_b32 s61, s33
    s_mov_b32 s62, 245760
    s_mov_b32 s63, 0x20000
    s_mov_b32 s64, s34
    s_mov_b32 s65, s35
    s_mov_b32 s66, 245760
    s_mov_b32 s67, 0x20000
    buffer_load_ushort v28, off, s[68:71], s9
    buffer_load_ushort v16, v8, s[52:55], s8 offen offset:0
    buffer_load_ushort v17, v8, s[56:59], s8 offen offset:0
    buffer_load_ushort v18, v8, s[60:63], s8 offen offset:0
    buffer_load_ushort v19, v8, s[64:67], s8 offen offset:0
    buffer_load_ushort v20, v8, s[52:55], s8 offen offset:128
    buffer_load_ushort v21, v8, s[56:59], s8 offen offset:128
    buffer_load_ushort v22, v8, s[60:63], s8 offen offset:128
    buffer_load_ushort v23, v8, s[64:67], s8 offen offset:128
    buffer_load_ushort v24, v8, s[52:55], s8 offen offset:256
    buffer_load_ushort v25, v8, s[56:59], s8 offen offset:256
    buffer_load_ushort v26, v8, s[60:63], s8 offen offset:256
    buffer_load_ushort v27, v8, s[64:67], s8 offen offset:256
    s_mov_b32 s89, 0x3fb8aa3b
    s_mov_b32 s90, 0x32a57060
    s_mov_b32 s91, 0x3f317218
    v_mov_b64 v[36:37], 0
    v_mov_b64 v[38:39], 0
    v_mov_b64 v[40:41], 0
    v_mov_b64 v[42:43], 0
    v_mov_b64 v[44:45], 0
    v_mov_b64 v[46:47], 0
    v_mov_b64 v[48:49], 0
    v_mov_b64 v[50:51], 0
    v_mov_b64 v[52:53], 0
    v_mov_b64 v[54:55], 0
    v_mov_b64 v[56:57], 0
    v_mov_b64 v[58:59], 0
    v_mov_b64 v[60:61], 0
    v_mov_b64 v[62:63], 0
    v_mov_b64 v[64:65], 0
    v_mov_b64 v[66:67], 0
    v_mov_b64 v[68:69], 0
    v_mov_b64 v[70:71], 0
    v_mov_b64 v[72:73], 0
    v_mov_b64 v[74:75], 0
    v_mov_b64 v[76:77], 0
    v_mov_b64 v[78:79], 0
    v_mov_b64 v[80:81], 0
    v_mov_b64 v[82:83], 0
    v_mov_b64 v[84:85], 0
    v_mov_b64 v[86:87], 0
    v_mov_b64 v[88:89], 0
    v_mov_b64 v[90:91], 0
    v_mov_b64 v[92:93], 0
    v_mov_b64 v[94:95], 0
    v_mov_b64 v[96:97], 0
    v_mov_b64 v[98:99], 0
    v_mov_b64 v[100:101], 0
    v_mov_b64 v[102:103], 0
    v_mov_b64 v[104:105], 0
    v_mov_b64 v[106:107], 0
    v_mov_b64 v[108:109], 0
    v_mov_b64 v[110:111], 0
    v_mov_b64 v[112:113], 0
    v_mov_b64 v[114:115], 0
    s_waitcnt vmcnt(12)
    v_lshlrev_b32 v28, 16, v28
    v_mul_f32 v8, s89, v28
    v_fma_f32 v9, v28, s89, -v8
    v_fmac_f32 v9, s90, v28
    v_exp_f32 v8, v8
    v_mul_f32 v9, s91, v9
    v_fmac_f32 v8, v8, v9
    v_cvt_pk_bf16_f32 v30, v8, v8
    v_and_b32 v30, 0xffff0000, v30
    s_mov_b32 s83, 3
    s_waitcnt vmcnt(0)
.p2align 6
L_kg_loop:
    v_lshlrev_b32 v8, 16, v16
    v_lshlrev_b32 v9, 16, v17
    v_lshlrev_b32 v138, 16, v18
    v_lshlrev_b32 v139, 16, v19
    v_mov_b64 v[16:17], v[20:21]
    v_mov_b64 v[18:19], v[22:23]
    v_mov_b64 v[20:21], v[24:25]
    v_mov_b64 v[22:23], v[26:27]
    v_mul_f32 v11, s89, v8
    v_fma_f32 v12, v8, s89, -v11
    v_fmac_f32 v12, s90, v8
    v_exp_f32 v11, v11
    v_mul_f32 v12, s91, v12
    v_fmac_f32 v11, v11, v12
    v_cvt_pk_bf16_f32 v10, v11, v11
    v_and_b32 v10, 0xffff0000, v10
    v_mul_f32 v10, v10, v30
    v_mul_f32 v9, v9, v30
    v_mul_f32 v10, 0xbfb8aa3b, v10
    v_mul_f32 v9, 0.15915494, v9
    v_add_f32 v8, v30, v30
    v_mul_f32 v138, v138, v8
    v_mul_f32 v139, v139, v8
    s_waitcnt lgkmcnt(0)
    v_mfma_f32_32x32x16_bf16 v[36:51], v[52:55], v[84:87], v[36:51]
    v_mul_f32 v11, 0x41000000, v10
    v_mul_f32 v12, 0x41000000, v9
    v_exp_f32 v11, v11
    v_fract_f32 v12, v12
    v_cos_f32 v13, v12
    v_sin_f32 v14, v12
    s_nop 0
    v_mul_f32 v118, v11, v13
    v_mul_f32 v119, v11, v14
    v_mfma_f32_32x32x16_bf16 v[36:51], v[56:59], v[88:91], v[36:51]
    v_exp_f32 v11, v10
    v_fract_f32 v12, v9
    v_cos_f32 v13, v12
    v_sin_f32 v14, v12
    s_nop 0
    v_mul_f32 v116, v11, v13
    v_mul_f32 v117, v11, v14
    v_mfma_f32_32x32x16_bf16 v[36:51], v[60:63], v[92:95], v[36:51]
    v_mul_f32 v11, 0x43800000, v10
    v_mul_f32 v12, 0x43800000, v9
    v_exp_f32 v11, v11
    v_fract_f32 v12, v12
    v_cos_f32 v13, v12
    v_sin_f32 v14, v12
    s_nop 0
    v_mul_f32 v122, v11, v13
    v_mul_f32 v123, v11, v14
    v_mov_b32 v134, 1.0
    v_mov_b32 v135, 0
    v_pk_mul_f32 v[148:149], v[118:119], v[118:119] op_sel:[0,0] op_sel_hi:[0,1]
    v_pk_fma_f32 v[120:121], v[118:119], v[118:119], v[148:149] op_sel:[1,1,0] op_sel_hi:[1,0,1] neg_lo:[1,0,0]
    v_mfma_f32_32x32x16_bf16 v[36:51], v[64:67], v[96:99], v[36:51]
    v_cvt_pk_bf16_f32 v8, v134, v118
    v_cvt_pk_bf16_f32 v12, v135, v119
    v_pk_mul_f32 v[150:151], v[118:119], v[120:121] op_sel:[0,0] op_sel_hi:[0,1]
    v_pk_fma_f32 v[136:137], v[118:119], v[120:121], v[150:151] op_sel:[1,1,0] op_sel_hi:[1,0,1] neg_lo:[1,0,0]
    v_cvt_pk_bf16_f32 v9, v120, v136
    v_cvt_pk_bf16_f32 v13, v121, v137
    v_pk_mul_f32 v[148:149], v[120:121], v[120:121] op_sel:[0,0] op_sel_hi:[0,1]
    v_pk_fma_f32 v[134:135], v[120:121], v[120:121], v[148:149] op_sel:[1,1,0] op_sel_hi:[1,0,1] neg_lo:[1,0,0]
    v_pk_mul_f32 v[150:151], v[136:137], v[120:121] op_sel:[0,0] op_sel_hi:[0,1]
    v_pk_fma_f32 v[136:137], v[136:137], v[120:121], v[150:151] op_sel:[1,1,0] op_sel_hi:[1,0,1] neg_lo:[1,0,0]
    v_mfma_f32_32x32x16_bf16 v[36:51], v[68:71], v[100:103], v[36:51]
    v_cvt_pk_bf16_f32 v10, v134, v136
    v_cvt_pk_bf16_f32 v14, v135, v137
    v_pk_mul_f32 v[148:149], v[134:135], v[120:121] op_sel:[0,0] op_sel_hi:[0,1]
    v_pk_fma_f32 v[134:135], v[134:135], v[120:121], v[148:149] op_sel:[1,1,0] op_sel_hi:[1,0,1] neg_lo:[1,0,0]
    v_pk_mul_f32 v[150:151], v[136:137], v[120:121] op_sel:[0,0] op_sel_hi:[0,1]
    v_pk_fma_f32 v[136:137], v[136:137], v[120:121], v[150:151] op_sel:[1,1,0] op_sel_hi:[1,0,1] neg_lo:[1,0,0]
    v_cvt_pk_bf16_f32 v11, v134, v136
    v_cvt_pk_bf16_f32 v15, v135, v137
    v_pk_mul_f32 v[148:149], v[134:135], v[120:121] op_sel:[0,0] op_sel_hi:[0,1]
    v_pk_fma_f32 v[134:135], v[134:135], v[120:121], v[148:149] op_sel:[1,1,0] op_sel_hi:[1,0,1] neg_lo:[1,0,0]
    ds_write_b128 v156, v[8:11]
    ds_write_b128 v160, v[12:15]
    v_pk_mul_f32 v[150:151], v[136:137], v[120:121] op_sel:[0,0] op_sel_hi:[0,1]
    v_pk_fma_f32 v[136:137], v[136:137], v[120:121], v[150:151] op_sel:[1,1,0] op_sel_hi:[1,0,1] neg_lo:[1,0,0]
    v_mfma_f32_32x32x16_bf16 v[36:51], v[72:75], v[104:107], v[36:51]
    v_cvt_pk_bf16_f32 v8, v134, v136
    v_cvt_pk_bf16_f32 v12, v135, v137
    v_pk_mul_f32 v[148:149], v[134:135], v[120:121] op_sel:[0,0] op_sel_hi:[0,1]
    v_pk_fma_f32 v[134:135], v[134:135], v[120:121], v[148:149] op_sel:[1,1,0] op_sel_hi:[1,0,1] neg_lo:[1,0,0]
    v_pk_mul_f32 v[150:151], v[136:137], v[120:121] op_sel:[0,0] op_sel_hi:[0,1]
    v_pk_fma_f32 v[136:137], v[136:137], v[120:121], v[150:151] op_sel:[1,1,0] op_sel_hi:[1,0,1] neg_lo:[1,0,0]
    v_cvt_pk_bf16_f32 v9, v134, v136
    v_cvt_pk_bf16_f32 v13, v135, v137
    v_pk_mul_f32 v[148:149], v[134:135], v[120:121] op_sel:[0,0] op_sel_hi:[0,1]
    v_pk_fma_f32 v[134:135], v[134:135], v[120:121], v[148:149] op_sel:[1,1,0] op_sel_hi:[1,0,1] neg_lo:[1,0,0]
    v_pk_mul_f32 v[150:151], v[136:137], v[120:121] op_sel:[0,0] op_sel_hi:[0,1]
    v_pk_fma_f32 v[136:137], v[136:137], v[120:121], v[150:151] op_sel:[1,1,0] op_sel_hi:[1,0,1] neg_lo:[1,0,0]
    v_mfma_f32_32x32x16_bf16 v[36:51], v[76:79], v[108:111], v[36:51]
    v_cvt_pk_bf16_f32 v10, v134, v136
    v_cvt_pk_bf16_f32 v14, v135, v137
    v_pk_mul_f32 v[148:149], v[134:135], v[120:121] op_sel:[0,0] op_sel_hi:[0,1]
    v_pk_fma_f32 v[134:135], v[134:135], v[120:121], v[148:149] op_sel:[1,1,0] op_sel_hi:[1,0,1] neg_lo:[1,0,0]
    v_pk_mul_f32 v[150:151], v[136:137], v[120:121] op_sel:[0,0] op_sel_hi:[0,1]
    v_pk_fma_f32 v[136:137], v[136:137], v[120:121], v[150:151] op_sel:[1,1,0] op_sel_hi:[1,0,1] neg_lo:[1,0,0]
    v_cvt_pk_bf16_f32 v11, v134, v136
    v_cvt_pk_bf16_f32 v15, v135, v137
    v_pk_mul_f32 v[148:149], v[134:135], v[120:121] op_sel:[0,0] op_sel_hi:[0,1]
    v_pk_fma_f32 v[134:135], v[134:135], v[120:121], v[148:149] op_sel:[1,1,0] op_sel_hi:[1,0,1] neg_lo:[1,0,0]
    ds_write_b128 v157, v[8:11]
    ds_write_b128 v161, v[12:15]
    v_pk_mul_f32 v[150:151], v[136:137], v[120:121] op_sel:[0,0] op_sel_hi:[0,1]
    v_pk_fma_f32 v[136:137], v[136:137], v[120:121], v[150:151] op_sel:[1,1,0] op_sel_hi:[1,0,1] neg_lo:[1,0,0]
    v_mfma_f32_32x32x16_bf16 v[36:51], v[80:83], v[112:115], v[36:51]
    v_cvt_pk_bf16_f32 v8, v134, v136
    v_cvt_pk_bf16_f32 v12, v135, v137
    v_pk_mul_f32 v[148:149], v[134:135], v[120:121] op_sel:[0,0] op_sel_hi:[0,1]
    v_pk_fma_f32 v[134:135], v[134:135], v[120:121], v[148:149] op_sel:[1,1,0] op_sel_hi:[1,0,1] neg_lo:[1,0,0]
    v_pk_mul_f32 v[150:151], v[136:137], v[120:121] op_sel:[0,0] op_sel_hi:[0,1]
    v_pk_fma_f32 v[136:137], v[136:137], v[120:121], v[150:151] op_sel:[1,1,0] op_sel_hi:[1,0,1] neg_lo:[1,0,0]
    v_cvt_pk_bf16_f32 v9, v134, v136
    v_cvt_pk_bf16_f32 v13, v135, v137
    v_pk_mul_f32 v[148:149], v[134:135], v[120:121] op_sel:[0,0] op_sel_hi:[0,1]
    v_pk_fma_f32 v[134:135], v[134:135], v[120:121], v[148:149] op_sel:[1,1,0] op_sel_hi:[1,0,1] neg_lo:[1,0,0]
    v_pk_mul_f32 v[150:151], v[136:137], v[120:121] op_sel:[0,0] op_sel_hi:[0,1]
    v_pk_fma_f32 v[136:137], v[136:137], v[120:121], v[150:151] op_sel:[1,1,0] op_sel_hi:[1,0,1] neg_lo:[1,0,0]
    v_cvt_pk_bf16_f32 v10, v134, v136
    v_cvt_pk_bf16_f32 v14, v135, v137
    v_pk_mul_f32 v[148:149], v[134:135], v[120:121] op_sel:[0,0] op_sel_hi:[0,1]
    v_pk_fma_f32 v[134:135], v[134:135], v[120:121], v[148:149] op_sel:[1,1,0] op_sel_hi:[1,0,1] neg_lo:[1,0,0]
    v_pk_mul_f32 v[150:151], v[136:137], v[120:121] op_sel:[0,0] op_sel_hi:[0,1]
    v_pk_fma_f32 v[136:137], v[136:137], v[120:121], v[150:151] op_sel:[1,1,0] op_sel_hi:[1,0,1] neg_lo:[1,0,0]
    v_cvt_pk_bf16_f32 v11, v134, v136
    v_cvt_pk_bf16_f32 v15, v135, v137
    v_pk_mul_f32 v[148:149], v[134:135], v[120:121] op_sel:[0,0] op_sel_hi:[0,1]
    v_pk_fma_f32 v[134:135], v[134:135], v[120:121], v[148:149] op_sel:[1,1,0] op_sel_hi:[1,0,1] neg_lo:[1,0,0]
    ds_write_b128 v158, v[8:11]
    ds_write_b128 v162, v[12:15]
    v_pk_mul_f32 v[150:151], v[136:137], v[120:121] op_sel:[0,0] op_sel_hi:[0,1]
    v_pk_fma_f32 v[136:137], v[136:137], v[120:121], v[150:151] op_sel:[1,1,0] op_sel_hi:[1,0,1] neg_lo:[1,0,0]
    v_cvt_pk_bf16_f32 v8, v134, v136
    v_cvt_pk_bf16_f32 v12, v135, v137
    v_pk_mul_f32 v[148:149], v[134:135], v[120:121] op_sel:[0,0] op_sel_hi:[0,1]
    v_pk_fma_f32 v[134:135], v[134:135], v[120:121], v[148:149] op_sel:[1,1,0] op_sel_hi:[1,0,1] neg_lo:[1,0,0]
    v_pk_mul_f32 v[150:151], v[136:137], v[120:121] op_sel:[0,0] op_sel_hi:[0,1]
    v_pk_fma_f32 v[136:137], v[136:137], v[120:121], v[150:151] op_sel:[1,1,0] op_sel_hi:[1,0,1] neg_lo:[1,0,0]
    v_cvt_pk_bf16_f32 v9, v134, v136
    v_cvt_pk_bf16_f32 v13, v135, v137
    v_pk_mul_f32 v[148:149], v[134:135], v[120:121] op_sel:[0,0] op_sel_hi:[0,1]
    v_pk_fma_f32 v[134:135], v[134:135], v[120:121], v[148:149] op_sel:[1,1,0] op_sel_hi:[1,0,1] neg_lo:[1,0,0]
    v_pk_mul_f32 v[150:151], v[136:137], v[120:121] op_sel:[0,0] op_sel_hi:[0,1]
    v_pk_fma_f32 v[136:137], v[136:137], v[120:121], v[150:151] op_sel:[1,1,0] op_sel_hi:[1,0,1] neg_lo:[1,0,0]
    v_cvt_pk_bf16_f32 v10, v134, v136
    v_cvt_pk_bf16_f32 v14, v135, v137
    v_pk_mul_f32 v[148:149], v[134:135], v[120:121] op_sel:[0,0] op_sel_hi:[0,1]
    v_pk_fma_f32 v[134:135], v[134:135], v[120:121], v[148:149] op_sel:[1,1,0] op_sel_hi:[1,0,1] neg_lo:[1,0,0]
    v_pk_mul_f32 v[150:151], v[136:137], v[120:121] op_sel:[0,0] op_sel_hi:[0,1]
    v_pk_fma_f32 v[136:137], v[136:137], v[120:121], v[150:151] op_sel:[1,1,0] op_sel_hi:[1,0,1] neg_lo:[1,0,0]
    v_cvt_pk_bf16_f32 v11, v134, v136
    v_cvt_pk_bf16_f32 v15, v135, v137
    ds_write_b128 v159, v[8:11]
    ds_write_b128 v163, v[12:15]
    ds_read_b64_tr_b16 v[52:53], v31 offset:0
    ds_read_b64_tr_b16 v[54:55], v32 offset:0
    ds_read_b64_tr_b16 v[56:57], v31 offset:1024
    ds_read_b64_tr_b16 v[58:59], v32 offset:1024
    ds_read_b64_tr_b16 v[60:61], v31 offset:2048
    ds_read_b64_tr_b16 v[62:63], v32 offset:2048
    ds_read_b64_tr_b16 v[64:65], v31 offset:3072
    ds_read_b64_tr_b16 v[66:67], v32 offset:3072
    ds_read_b64_tr_b16 v[68:69], v31 offset:4096
    ds_read_b64_tr_b16 v[70:71], v32 offset:4096
    ds_read_b64_tr_b16 v[72:73], v31 offset:5120
    ds_read_b64_tr_b16 v[74:75], v32 offset:5120
    ds_read_b64_tr_b16 v[76:77], v31 offset:6144
    ds_read_b64_tr_b16 v[78:79], v32 offset:6144
    ds_read_b64_tr_b16 v[80:81], v31 offset:7168
    ds_read_b64_tr_b16 v[82:83], v32 offset:7168
    v_pk_mul_f32 v[148:149], v[138:139], v[116:117] op_sel:[0,0] op_sel_hi:[0,1]
    v_pk_fma_f32 v[146:147], v[138:139], v[116:117], v[148:149] op_sel:[1,1,0] op_sel_hi:[1,0,1] neg_lo:[1,0,0]
    v_pk_mul_f32 v[150:151], v[122:123], v[122:123] op_sel:[0,0] op_sel_hi:[0,1]
    v_pk_fma_f32 v[124:125], v[122:123], v[122:123], v[150:151] op_sel:[1,1,0] op_sel_hi:[1,0,1] neg_lo:[1,0,0]
    v_cvt_pk_bf16_f32 v8, v138, v146
    v_cvt_pk_bf16_f32 v12, -v139, -v147
    v_pk_mul_f32 v[148:149], v[146:147], v[116:117] op_sel:[0,0] op_sel_hi:[0,1]
    v_pk_fma_f32 v[140:141], v[146:147], v[116:117], v[148:149] op_sel:[1,1,0] op_sel_hi:[1,0,1] neg_lo:[1,0,0]
    v_pk_mul_f32 v[150:151], v[124:125], v[122:123] op_sel:[0,0] op_sel_hi:[0,1]
    v_pk_fma_f32 v[126:127], v[124:125], v[122:123], v[150:151] op_sel:[1,1,0] op_sel_hi:[1,0,1] neg_lo:[1,0,0]
    v_pk_mul_f32 v[148:149], v[140:141], v[116:117] op_sel:[0,0] op_sel_hi:[0,1]
    v_pk_fma_f32 v[146:147], v[140:141], v[116:117], v[148:149] op_sel:[1,1,0] op_sel_hi:[1,0,1] neg_lo:[1,0,0]
    v_pk_mul_f32 v[150:151], v[124:125], v[124:125] op_sel:[0,0] op_sel_hi:[0,1]
    v_pk_fma_f32 v[128:129], v[124:125], v[124:125], v[150:151] op_sel:[1,1,0] op_sel_hi:[1,0,1] neg_lo:[1,0,0]
    v_cvt_pk_bf16_f32 v9, v140, v146
    v_cvt_pk_bf16_f32 v13, -v141, -v147
    v_pk_mul_f32 v[148:149], v[146:147], v[116:117] op_sel:[0,0] op_sel_hi:[0,1]
    v_pk_fma_f32 v[142:143], v[146:147], v[116:117], v[148:149] op_sel:[1,1,0] op_sel_hi:[1,0,1] neg_lo:[1,0,0]
    v_pk_mul_f32 v[150:151], v[138:139], v[122:123] op_sel:[0,0] op_sel_hi:[0,1]
    v_pk_fma_f32 v[130:131], v[138:139], v[122:123], v[150:151] op_sel:[1,1,0] op_sel_hi:[1,0,1] neg_lo:[1,0,0]
    v_pk_mul_f32 v[148:149], v[142:143], v[116:117] op_sel:[0,0] op_sel_hi:[0,1]
    v_pk_fma_f32 v[146:147], v[142:143], v[116:117], v[148:149] op_sel:[1,1,0] op_sel_hi:[1,0,1] neg_lo:[1,0,0]
    v_pk_mul_f32 v[150:151], v[140:141], v[122:123] op_sel:[0,0] op_sel_hi:[0,1]
    v_pk_fma_f32 v[132:133], v[140:141], v[122:123], v[150:151] op_sel:[1,1,0] op_sel_hi:[1,0,1] neg_lo:[1,0,0]
    v_cvt_pk_bf16_f32 v10, v142, v146
    v_cvt_pk_bf16_f32 v14, -v143, -v147
    v_pk_mul_f32 v[148:149], v[146:147], v[116:117] op_sel:[0,0] op_sel_hi:[0,1]
    v_pk_fma_f32 v[144:145], v[146:147], v[116:117], v[148:149] op_sel:[1,1,0] op_sel_hi:[1,0,1] neg_lo:[1,0,0]
    v_pk_mul_f32 v[150:151], v[142:143], v[122:123] op_sel:[0,0] op_sel_hi:[0,1]
    v_pk_fma_f32 v[134:135], v[142:143], v[122:123], v[150:151] op_sel:[1,1,0] op_sel_hi:[1,0,1] neg_lo:[1,0,0]
    v_pk_mul_f32 v[148:149], v[144:145], v[116:117] op_sel:[0,0] op_sel_hi:[0,1]
    v_pk_fma_f32 v[146:147], v[144:145], v[116:117], v[148:149] op_sel:[1,1,0] op_sel_hi:[1,0,1] neg_lo:[1,0,0]
    v_pk_mul_f32 v[150:151], v[144:145], v[122:123] op_sel:[0,0] op_sel_hi:[0,1]
    v_pk_fma_f32 v[136:137], v[144:145], v[122:123], v[150:151] op_sel:[1,1,0] op_sel_hi:[1,0,1] neg_lo:[1,0,0]
    v_cvt_pk_bf16_f32 v11, v144, v146
    v_cvt_pk_bf16_f32 v15, -v145, -v147
    ds_write_b128 v156, v[8:11]
    ds_write_b128 v160, v[12:15]
    v_cvt_pk_bf16_f32 v8, v130, v132
    v_cvt_pk_bf16_f32 v12, -v131, -v133
    v_cvt_pk_bf16_f32 v9, v134, v136
    v_cvt_pk_bf16_f32 v13, -v135, -v137
    v_pk_mul_f32 v[148:149], v[138:139], v[124:125] op_sel:[0,0] op_sel_hi:[0,1]
    v_pk_fma_f32 v[130:131], v[138:139], v[124:125], v[148:149] op_sel:[1,1,0] op_sel_hi:[1,0,1] neg_lo:[1,0,0]
    v_pk_mul_f32 v[150:151], v[142:143], v[124:125] op_sel:[0,0] op_sel_hi:[0,1]
    v_pk_fma_f32 v[132:133], v[142:143], v[124:125], v[150:151] op_sel:[1,1,0] op_sel_hi:[1,0,1] neg_lo:[1,0,0]
    v_pk_mul_f32 v[148:149], v[138:139], v[126:127] op_sel:[0,0] op_sel_hi:[0,1]
    v_pk_fma_f32 v[134:135], v[138:139], v[126:127], v[148:149] op_sel:[1,1,0] op_sel_hi:[1,0,1] neg_lo:[1,0,0]
    v_pk_mul_f32 v[150:151], v[142:143], v[126:127] op_sel:[0,0] op_sel_hi:[0,1]
    v_pk_fma_f32 v[136:137], v[142:143], v[126:127], v[150:151] op_sel:[1,1,0] op_sel_hi:[1,0,1] neg_lo:[1,0,0]
    v_cvt_pk_bf16_f32 v10, v130, v132
    v_cvt_pk_bf16_f32 v14, -v131, -v133
    v_pk_mul_f32 v[148:149], v[138:139], v[128:129] op_sel:[0,0] op_sel_hi:[0,1]
    v_pk_fma_f32 v[140:141], v[138:139], v[128:129], v[148:149] op_sel:[1,1,0] op_sel_hi:[1,0,1] neg_lo:[1,0,0]
    v_cvt_pk_bf16_f32 v11, v134, v136
    v_cvt_pk_bf16_f32 v15, -v135, -v137
    ds_write_b128 v157, v[8:11]
    ds_write_b128 v161, v[12:15]
    v_pk_mul_f32 v[150:151], v[140:141], v[122:123] op_sel:[0,0] op_sel_hi:[0,1]
    v_pk_fma_f32 v[130:131], v[140:141], v[122:123], v[150:151] op_sel:[1,1,0] op_sel_hi:[1,0,1] neg_lo:[1,0,0]
    v_pk_mul_f32 v[148:149], v[140:141], v[124:125] op_sel:[0,0] op_sel_hi:[0,1]
    v_pk_fma_f32 v[132:133], v[140:141], v[124:125], v[148:149] op_sel:[1,1,0] op_sel_hi:[1,0,1] neg_lo:[1,0,0]
    v_pk_mul_f32 v[150:151], v[140:141], v[126:127] op_sel:[0,0] op_sel_hi:[0,1]
    v_pk_fma_f32 v[134:135], v[140:141], v[126:127], v[150:151] op_sel:[1,1,0] op_sel_hi:[1,0,1] neg_lo:[1,0,0]
    v_pk_mul_f32 v[148:149], v[140:141], v[128:129] op_sel:[0,0] op_sel_hi:[0,1]
    v_pk_fma_f32 v[136:137], v[140:141], v[128:129], v[148:149] op_sel:[1,1,0] op_sel_hi:[1,0,1] neg_lo:[1,0,0]
    v_cvt_pk_bf16_f32 v8, v140, v130
    v_cvt_pk_bf16_f32 v12, -v141, -v131
    v_cvt_pk_bf16_f32 v9, v132, v134
    v_cvt_pk_bf16_f32 v13, -v133, -v135
    v_cvt_pk_bf16_f32 v10, v136, v136
    v_cvt_pk_bf16_f32 v14, -v137, -v137
    ds_write_b128 v158, v[8:11]
    ds_write_b128 v162, v[12:15]
    ds_read_b64_tr_b16 v[84:85], v31 offset:0
    ds_read_b64_tr_b16 v[86:87], v32 offset:0
    ds_read_b64_tr_b16 v[88:89], v31 offset:1024
    ds_read_b64_tr_b16 v[90:91], v32 offset:1024
    ds_read_b64_tr_b16 v[92:93], v31 offset:2048
    ds_read_b64_tr_b16 v[94:95], v32 offset:2048
    ds_read_b64_tr_b16 v[96:97], v31 offset:3072
    ds_read_b64_tr_b16 v[98:99], v32 offset:3072
    ds_read_b64_tr_b16 v[100:101], v31 offset:4096
    ds_read_b64_tr_b16 v[102:103], v32 offset:4096
    ds_read_b64_tr_b16 v[104:105], v31 offset:5120
    ds_read_b64_tr_b16 v[106:107], v32 offset:5120
    ds_read_b64_tr_b16 v[108:109], v31 offset:6144
    ds_read_b64_tr_b16 v[110:111], v32 offset:6144
    ds_read_b64_tr_b16 v[112:113], v31 offset:7168
    ds_read_b64_tr_b16 v[114:115], v32 offset:7168
    s_sub_u32 s83, s83, 1
    s_cmp_lg_u32 s83, 0
    s_cbranch_scc1 L_kg_loop
    s_setprio 0
    s_mov_b32 s82, 400000
L_w_90:
    ds_read_b32 v33, v2 offset:36
    s_waitcnt lgkmcnt(0)
    v_readfirstlane_b32 s15, v33
    s_cmp_ge_u32 s15, 1
    s_cbranch_scc1 L_wd_91
    s_sleep 1
    s_sub_u32 s82, s82, 1
    s_cmp_lg_u32 s82, 0
    s_cbranch_scc1 L_w_90
L_wd_91:
    s_setprio 3
    s_mov_b32 s7, s15
    v_and_b32 v34, 31, v1
    v_lshlrev_b32 v34, 10, v34
    s_lshl_b32 s90, s6, 7
    s_add_u32 s90, s90, 36864
    buffer_load_dword v164, v34, s[48:51], s90 offen sc1
    v_and_b32 v4, 31, v1
    v_mul_u32_u24 v4, 144, v4
    v_lshrrev_b32 v5, 5, v1
    v_lshl_add_u32 v4, v5, 4, v4
    v_add_u32 v8, s88, v4
    s_waitcnt lgkmcnt(0)
    v_mfma_f32_32x32x16_bf16 v[36:51], v[52:55], v[84:87], v[36:51]
    v_and_b32 v4, 1, v1
    v_lshrrev_b32 v5, 1, v1
    v_lshlrev_b32 v5, 2, v5
    v_add_u32 v5, s88, v5
    v_mov_b32 v6, 576
    v_mad_u32_u24 v9, v4, v6, v5
    v_mfma_f32_32x32x16_bf16 v[36:51], v[56:59], v[88:91], v[36:51]
    v_mov_b32 v6, 288
    v_mad_u32_u24 v10, v4, v6, v5
    v_lshrrev_b32 v4, 5, v1
    v_mul_u32_u24 v4, 288, v4
    v_and_b32 v5, 31, v1
    v_lshl_add_u32 v4, v5, 2, v4
    v_mfma_f32_32x32x16_bf16 v[36:51], v[60:63], v[92:95], v[36:51]
    v_add_u32 v11, s88, v4
    v_lshrrev_b32 v4, 4, v1
    v_mul_u32_u24 v4, 144, v4
    v_and_b32 v5, 15, v1
    v_lshl_add_u32 v4, v5, 3, v4
    v_add_u32 v12, s88, v4
    v_mfma_f32_32x32x16_bf16 v[36:51], v[64:67], v[96:99], v[36:51]
    v_mov_b32 v13, s88
    v_lshlrev_b32 v4, 3, v1
    v_sub_u32 v116, s88, v4
    v_add_u32 v116, 4088, v116
    v_lshlrev_b32 v4, 4, v1
    v_sub_u32 v120, s88, v4
    v_mfma_f32_32x32x16_bf16 v[36:51], v[68:71], v[100:103], v[36:51]
    v_add_u32 v120, 3056, v120
    v_lshlrev_b32 v4, 5, v1
    v_sub_u32 v122, s88, v4
    v_add_u32 v122, 2016, v122
    v_add_u32 v117, 4160, v116
    v_add_u32 v121, 4160, v120
    v_mfma_f32_32x32x16_bf16 v[36:51], v[72:75], v[104:107], v[36:51]
    v_add_u32 v123, 4160, v122
    v_subrev_u32 v118, 512, v116
    v_subrev_u32 v119, 512, v117
    v_lshl_add_u32 v124, v1, 2, s88
    v_cmp_eq_u32 s[84:85], 0, v1
    v_mfma_f32_32x32x16_bf16 v[36:51], v[76:79], v[108:111], v[36:51]
    s_mul_i32 s89, s81, 4608
    s_add_u32 s89, s89, 108544
    v_lshlrev_b32 v35, 4, v1
    v_lshl_add_u32 v33, v1, 3, s89
    v_mfma_f32_32x32x16_bf16 v[36:51], v[80:83], v[112:115], v[36:51]
    s_nop 11
    ds_write_b128 v8, v[36:39] offset:0
    ds_write_b128 v8, v[40:43] offset:32
    ds_write_b128 v8, v[44:47] offset:64
    ds_write_b128 v8, v[48:51] offset:96
    ds_read_b32 v52, v9 offset:0
    ds_read_b32 v53, v9 offset:144
    ds_read_b32 v54, v9 offset:288
    ds_read_b32 v55, v9 offset:432
    ds_read_b32 v57, v10 offset:1152
    ds_read_b32 v58, v10 offset:1296
    ds_read_b32 v59, v13 offset:1728
    ds_read_b32 v60, v13 offset:1132
    ds_read_b32 v61, v11 offset:1728
    ds_read_b32 v62, v11 offset:1872
    ds_read_b32 v63, v13 offset:2304
    ds_read_b64 v[64:65], v12 offset:2304
    ds_read_b32 v66, v13 offset:2880
    s_waitcnt vmcnt(0)
    v_cmp_ne_u32 vcc, s7, v164
    s_cbranch_vccz L_fu_go
    s_setprio 0
    s_mov_b32 s82, 400000
L_p_92:
    buffer_load_dword v164, v34, s[48:51], s90 offen sc1
    s_waitcnt vmcnt(0)
    v_cmp_ne_u32 vcc, s7, v164
    s_cbranch_vccz L_pd_93
    s_sleep 2
    s_sub_u32 s82, s82, 1
    s_cmp_lg_u32 s82, 0
    s_cbranch_scc1 L_p_92
L_pd_93:
    s_setprio 3
L_fu_go:
    s_setprio 0
    s_mov_b32 s82, 400000
L_w_94:
    ds_read_b32 v4, v2 offset:12
    s_waitcnt lgkmcnt(0)
    v_readfirstlane_b32 s15, v4
    s_cmp_ge_u32 s15, 8
    s_cbranch_scc1 L_wd_95
    s_sleep 1
    s_sub_u32 s82, s82, 1
    s_cmp_lg_u32 s82, 0
    s_cbranch_scc1 L_w_94
L_wd_95:
    s_setprio 3
    v_mov_b64 v[36:37], 0
    s_lshl_b32 s8, s80, 12
    s_add_u32 s8, s8, 1048576
    s_add_u32 m0, s89, 512
    ds_write_b64 v33, v[36:37]
    buffer_load_dwordx4 v35, s[48:51], s8 offen offset:0 sc1 lds
    buffer_load_dwordx4 v35, s[48:51], s8 offen offset:1024 sc1 lds
    buffer_load_dwordx4 v35, s[48:51], s8 offen offset:2048 sc1 lds
    buffer_load_dwordx4 v35, s[48:51], s8 offen offset:3072 sc1 lds
    s_waitcnt lgkmcnt(0)
    v_mov_b32_dpp v56, v55 wave_shr:1 row_mask:0xf bank_mask:0xf bound_ctrl:0
    v_mov_b32_dpp v59, v57 wave_shl:1 row_mask:0xf bank_mask:0xf
    v_mov_b32_dpp v63, v61 wave_shl:1 row_mask:0xf bank_mask:0xf
    v_mov_b32_dpp v66, v64 wave_shl:1 row_mask:0xf bank_mask:0xf
    v_cndmask_b32 v60, v57, v60, s[84:85]
    v_cvt_pk_bf16_f32 v68, v55, v54
    v_cvt_pk_bf16_f32 v69, v53, v52
    v_cvt_pk_bf16_f32 v70, v54, v53
    v_cvt_pk_bf16_f32 v71, v52, v56
    ds_write_b64 v116, v[68:69]
    ds_write_b64 v117, v[70:71]
    v_cvt_pk_bf16_f32 v72, v59, v58
    v_cvt_pk_bf16_f32 v73, v57, v57
    v_cvt_pk_bf16_f32 v74, v58, v57
    v_cvt_pk_bf16_f32 v75, v57, v60
    ds_write_b64 v118, v[72:73]
    ds_write_b64 v119, v[74:75]
    v_cvt_pk_bf16_f32 v76, v63, v63
    v_cvt_pk_bf16_f32 v77, v62, v62
    v_cvt_pk_bf16_f32 v78, v62, v61
    v_cvt_pk_bf16_f32 v79, v61, v61
    v_cvt_pk_bf16_f32 v80, v63, v62
    v_mov_b32 v81, v77
    v_mov_b32 v82, v79
    v_mov_b32 v83, v79
    ds_write_b128 v120, v[76:79]
    ds_write_b128 v121, v[80:83]
    v_cvt_pk_bf16_f32 v84, v66, v66
    v_cvt_pk_bf16_f32 v86, v65, v65
    v_cvt_pk_bf16_f32 v89, v65, v64
    v_cvt_pk_bf16_f32 v90, v64, v64
    v_cvt_pk_bf16_f32 v93, v66, v65
    v_mov_b32 v85, v84
    v_mov_b32 v87, v86
    v_mov_b32 v88, v86
    v_mov_b32 v91, v90
    v_mov_b32 v92, v84
    v_mov_b32 v94, v86
    v_mov_b32 v95, v86
    v_mov_b32 v96, v86
    v_mov_b32 v97, v90
    v_mov_b32 v98, v90
    v_mov_b32 v99, v90
    ds_write_b128 v122, v[84:87]
    ds_write_b128 v122, v[88:91] offset:16
    ds_write_b128 v123, v[92:95]
    ds_write_b128 v123, v[96:99] offset:16
    v_mov_b32 v36, 0
    v_mov_b32 v37, 0
    s_mov_b64 exec, 0xffff
    ds_write_b32 v124, v36 offset:4096
    ds_write_b32 v124, v36 offset:8256
    s_mov_b64 exec, -1
    s_mov_b32 s56, s38
    s_mov_b32 s57, s39
    s_mov_b32 s58, 1280
    s_mov_b32 s59, 0x20000
    s_lshl_b32 s8, s80, 1
    buffer_load_ushort v16, off, s[56:59], s8
    v_bfe_u32 v4, v1, 1, 3
    v_lshrrev_b32 v5, 4, v1
    v_lshlrev_b32 v6, 2, v5
    v_sub_u32 v4, v6, v4
    v_add_u32 v4, 887, v4
    v_lshlrev_b32 v4, 2, v4
    v_and_b32 v6, 1, v1
    v_xor_b32 v6, 1, v6
    v_mul_u32_u24 v6, 4160, v6
    v_add3_u32 v20, v4, v6, s88
    v_subrev_u32 v21, 1024, v20
    v_subrev_u32 v22, 2048, v20
    v_subrev_u32 v23, 3072, v20
    v_and_b32 v4, 15, v1
    v_lshlrev_b32 v6, 5, v4
    s_add_u32 s9, s89, 480
    v_lshl_add_u32 v24, v5, 4, v6
    v_add_u32 v24, s9, v24
    s_add_u32 s9, s89, 512
    v_lshl_add_u32 v25, v5, 3, v6
    v_add_u32 v25, s9, v25
    v_and_b32 v7, 1, v5
    v_lshrrev_b32 v6, 2, v4
    v_lshl_add_u32 v6, v7, 2, v6
    v_mul_u32_u24 v6, 81920, v6
    v_and_b32 v4, 3, v4
    v_lshl_add_u32 v6, v4, 5, v6
    v_lshrrev_b32 v5, 1, v5
    v_lshl_add_u32 v26, v5, 4, v6
    s_lshl_b32 s90, s80, 7
    s_add_u32 s90, s90, 4194304
    v_mov_b64 v[36:37], 0
    v_mov_b64 v[38:39], 0
    v_mov_b64 v[40:41], 0
    v_mov_b64 v[42:43], 0
    v_mov_b64 v[44:45], 0
    v_mov_b64 v[46:47], 0
    v_mov_b64 v[48:49], 0
    v_mov_b64 v[50:51], 0
    v_mov_b64 v[52:53], 0
    v_mov_b64 v[54:55], 0
    v_mov_b64 v[56:57], 0
    v_mov_b64 v[58:59], 0
    v_mov_b64 v[60:61], 0
    v_mov_b64 v[62:63], 0
    v_mov_b64 v[64:65], 0
    v_mov_b64 v[66:67], 0
    s_mov_b32 s83, 8
    s_waitcnt vmcnt(0) lgkmcnt(0)
    v_lshlrev_b32 v16, 16, v16
    s_setprio 0
    ds_read2_b32 v[68:69], v20 offset0:128 offset1:129
    ds_read2_b32 v[70:71], v20 offset0:130 offset1:131
    ds_read_b128 v[100:103], v24 offset:0
    ds_read2_b32 v[72:73], v20 offset0:0 offset1:1
    ds_read2_b32 v[74:75], v20 offset0:2 offset1:3
    ds_read_b128 v[104:107], v24 offset:512
    ds_read2_b32 v[96:97], v23 offset0:0 offset1:1
    ds_read2_b32 v[98:99], v23 offset0:2 offset1:3
    ds_read_b128 v[128:131], v24 offset:3584
    ds_read2_b32 v[92:93], v23 offset0:128 offset1:129
    ds_read2_b32 v[94:95], v23 offset0:130 offset1:131
    ds_read_b128 v[124:127], v24 offset:3072
    ds_read2_b32 v[88:89], v22 offset0:0 offset1:1
    ds_read2_b32 v[90:91], v22 offset0:2 offset1:3
    ds_read_b128 v[120:123], v24 offset:2560
    ds_read2_b32 v[84:85], v22 offset0:128 offset1:129
    ds_read2_b32 v[86:87], v22 offset0:130 offset1:131
    ds_read_b128 v[116:119], v24 offset:2048
    ds_read2_b32 v[80:81], v21 offset0:0 offset1:1
    ds_read2_b32 v[82:83], v21 offset0:2 offset1:3
    ds_read_b128 v[112:115], v24 offset:1536
    ds_read2_b32 v[76:77], v21 offset0:128 offset1:129
    ds_read2_b32 v[78:79], v21 offset0:130 offset1:131
    ds_read_b128 v[108:111], v24 offset:1024
    s_mov_b32 s83, 4
.p2align 6
L_cv:
    v_subrev_u32 v20, 64, v20
    v_subrev_u32 v21, 64, v21
    v_subrev_u32 v22, 64, v22
    v_subrev_u32 v23, 64, v23
    v_subrev_u32 v24, 64, v24
    s_waitcnt lgkmcnt(15)
    v_mfma_f32_16x16x32_bf16 v[64:67], v[96:99], v[100:103], v[64:67]
    v_mfma_f32_16x16x32_bf16 v[64:67], v[68:71], v[128:131], v[64:67]
    ds_read2_b32 v[132:133], v20 offset0:128 offset1:129
    ds_read2_b32 v[134:135], v20 offset0:130 offset1:131
    ds_read_b128 v[136:139], v24 offset:0
    ds_read2_b32 v[140:141], v20 offset0:0 offset1:1
    ds_read2_b32 v[142:143], v20 offset0:2 offset1:3
    ds_read_b128 v[144:147], v24 offset:512
    ds_read2_b32 v[96:97], v23 offset0:0 offset1:1
    ds_read2_b32 v[98:99], v23 offset0:2 offset1:3
    ds_read_b128 v[128:131], v24 offset:3584
    s_waitcnt lgkmcnt(15)
    v_mfma_f32_16x16x32_bf16 v[60:63], v[92:95], v[100:103], v[60:63]
    v_mfma_f32_16x16x32_bf16 v[60:63], v[68:71], v[124:127], v[60:63]
    v_mfma_f32_16x16x32_bf16 v[64:67], v[92:95], v[104:107], v[64:67]
    v_mfma_f32_16x16x32_bf16 v[64:67], v[72:75], v[124:127], v[64:67]
    ds_read2_b32 v[92:93], v23 offset0:128 offset1:129
    ds_read2_b32 v[94:95], v23 offset0:130 offset1:131
    ds_read_b128 v[124:127], v24 offset:3072
    s_waitcnt lgkmcnt(12)
    v_mfma_f32_16x16x32_bf16 v[56:59], v[88:91], v[100:103], v[56:59]
    v_mfma_f32_16x16x32_bf16 v[56:59], v[68:71], v[120:123], v[56:59]
    v_mfma_f32_16x16x32_bf16 v[60:63], v[88:91], v[104:107], v[60:63]
    v_mfma_f32_16x16x32_bf16 v[60:63], v[72:75], v[120:123], v[60:63]
    v_mfma_f32_16x16x32_bf16 v[64:67], v[88:91], v[108:111], v[64:67]
    v_mfma_f32_16x16x32_bf16 v[64:67], v[76:79], v[120:123], v[64:67]
    ds_read2_b32 v[88:89], v22 offset0:0 offset1:1
    ds_read2_b32 v[90:91], v22 offset0:2 offset1:3
    ds_read_b128 v[120:123], v24 offset:2560
    v_mfma_f32_16x16x32_bf16 v[52:55], v[84:87], v[100:103], v[52:55]
    v_mfma_f32_16x16x32_bf16 v[52:55], v[68:71], v[116:119], v[52:55]
    v_mfma_f32_16x16x32_bf16 v[56:59], v[84:87], v[104:107], v[56:59]
    v_mfma_f32_16x16x32_bf16 v[56:59], v[72:75], v[116:119], v[56:59]
    v_mfma_f32_16x16x32_bf16 v[60:63], v[84:87], v[108:111], v[60:63]
    v_mfma_f32_16x16x32_bf16 v[60:63], v[76:79], v[116:119], v[60:63]
    v_mfma_f32_16x16x32_bf16 v[64:67], v[84:87], v[112:115], v[64:67]
    v_mfma_f32_16x16x32_bf16 v[64:67], v[80:83], v[116:119], v[64:67]
    ds_read2_b32 v[84:85], v22 offset0:128 offset1:129
    ds_read2_b32 v[86:87], v22 offset0:130 offset1:131
    ds_read_b128 v[116:119], v24 offset:2048
    v_mfma_f32_16x16x32_bf16 v[48:51], v[80:83], v[100:103], v[48:51]
    v_mfma_f32_16x16x32_bf16 v[48:51], v[68:71], v[112:115], v[48:51]
    v_mfma_f32_16x16x32_bf16 v[52:55], v[80:83], v[104:107], v[52:55]
    v_mfma_f32_16x16x32_bf16 v[52:55], v[72:75], v[112:115], v[52:55]
    v_mfma_f32_16x16x32_bf16 v[56:59], v[80:83], v[108:111], v[56:59]
    v_mfma_f32_16x16x32_bf16 v[56:59], v[76:79], v[112:115], v[56:59]
    v_mfma_f32_16x16x32_bf16 v[60:63], v[80:83], v[112:115], v[60:63]
    ds_read2_b32 v[80:81], v21 offset0:0 offset1:1
    ds_read2_b32 v[82:83], v21 offset0:2 offset1:3
    ds_read_b128 v[112:115], v24 offset:1536
    v_mfma_f32_16x16x32_bf16 v[44:47], v[76:79], v[100:103], v[44:47]
    v_mfma_f32_16x16x32_bf16 v[44:47], v[68:71], v[108:111], v[44:47]
    v_mfma_f32_16x16x32_bf16 v[48:51], v[76:79], v[104:107], v[48:51]
    v_mfma_f32_16x16x32_bf16 v[48:51], v[72:75], v[108:111], v[48:51]
    v_mfma_f32_16x16x32_bf16 v[52:55], v[76:79], v[108:111], v[52:55]
    ds_read2_b32 v[76:77], v21 offset0:128 offset1:129
    ds_read2_b32 v[78:79], v21 offset0:130 offset1:131
    ds_read_b128 v[108:111], v24 offset:1024
    v_mfma_f32_16x16x32_bf16 v[40:43], v[72:75], v[100:103], v[40:43]
    v_mfma_f32_16x16x32_bf16 v[40:43], v[68:71], v[104:107], v[40:43]
    v_mfma_f32_16x16x32_bf16 v[44:47], v[72:75], v[104:107], v[44:47]
    v_mfma_f32_16x16x32_bf16 v[36:39], v[68:71], v[100:103], v[36:39]
    v_subrev_u32 v20, 64, v20
    v_subrev_u32 v21, 64, v21
    v_subrev_u32 v22, 64, v22
    v_subrev_u32 v23, 64, v23
    v_subrev_u32 v24, 64, v24
    s_waitcnt lgkmcnt(15)
    v_mfma_f32_16x16x32_bf16 v[64:67], v[96:99], v[136:139], v[64:67]
    v_mfma_f32_16x16x32_bf16 v[64:67], v[132:135], v[128:131], v[64:67]
    ds_read2_b32 v[68:69], v20 offset0:128 offset1:129
    ds_read2_b32 v[70:71], v20 offset0:130 offset1:131
    ds_read_b128 v[100:103], v24 offset:0
    ds_read2_b32 v[72:73], v20 offset0:0 offset1:1
    ds_read2_b32 v[74:75], v20 offset0:2 offset1:3
    ds_read_b128 v[104:107], v24 offset:512
    ds_read2_b32 v[96:97], v23 offset0:0 offset1:1
    ds_read2_b32 v[98:99], v23 offset0:2 offset1:3
    ds_read_b128 v[128:131], v24 offset:3584
    s_waitcnt lgkmcnt(15)
    v_mfma_f32_16x16x32_bf16 v[60:63], v[92:95], v[136:139], v[60:63]
    v_mfma_f32_16x16x32_bf16 v[60:63], v[132:135], v[124:127], v[60:63]
    v_mfma_f32_16x16x32_bf16 v[64:67], v[92:95], v[144:147], v[64:67]
    v_mfma_f32_16x16x32_bf16 v[64:67], v[140:143], v[124:127], v[64:67]
    ds_read2_b32 v[92:93], v23 offset0:128 offset1:129
    ds_read2_b32 v[94:95], v23 offset0:130 offset1:131
    ds_read_b128 v[124:127], v24 offset:3072
    s_waitcnt lgkmcnt(12)
    v_mfma_f32_16x16x32_bf16 v[56:59], v[88:91], v[136:139], v[56:59]
    v_mfma_f32_16x16x32_bf16 v[56:59], v[132:135], v[120:123], v[56:59]
    v_mfma_f32_16x16x32_bf16 v[60:63], v[88:91], v[144:147], v[60:63]
    v_mfma_f32_16x16x32_bf16 v[60:63], v[140:143], v[120:123], v[60:63]
    v_mfma_f32_16x16x32_bf16 v[64:67], v[88:91], v[108:111], v[64:67]
    v_mfma_f32_16x16x32_bf16 v[64:67], v[76:79], v[120:123], v[64:67]
    ds_read2_b32 v[88:89], v22 offset0:0 offset1:1
    ds_read2_b32 v[90:91], v22 offset0:2 offset1:3
    ds_read_b128 v[120:123], v24 offset:2560
    v_mfma_f32_16x16x32_bf16 v[52:55], v[84:87], v[136:139], v[52:55]
    v_mfma_f32_16x16x32_bf16 v[52:55], v[132:135], v[116:119], v[52:55]
    v_mfma_f32_16x16x32_bf16 v[56:59], v[84:87], v[144:147], v[56:59]
    v_mfma_f32_16x16x32_bf16 v[56:59], v[140:143], v[116:119], v[56:59]
    v_mfma_f32_16x16x32_bf16 v[60:63], v[84:87], v[108:111], v[60:63]
    v_mfma_f32_16x16x32_bf16 v[60:63], v[76:79], v[116:119], v[60:63]
    v_mfma_f32_16x16x32_bf16 v[64:67], v[84:87], v[112:115], v[64:67]
    v_mfma_f32_16x16x32_bf16 v[64:67], v[80:83], v[116:119], v[64:67]
    ds_read2_b32 v[84:85], v22 offset0:128 offset1:129
    ds_read2_b32 v[86:87], v22 offset0:130 offset1:131
    ds_read_b128 v[116:119], v24 offset:2048
    v_mfma_f32_16x16x32_bf16 v[48:51], v[80:83], v[136:139], v[48:51]
    v_mfma_f32_16x16x32_bf16 v[48:51], v[132:135], v[112:115], v[48:51]
    v_mfma_f32_16x16x32_bf16 v[52:55], v[80:83], v[144:147], v[52:55]
    v_mfma_f32_16x16x32_bf16 v[52:55], v[140:143], v[112:115], v[52:55]
    v_mfma_f32_16x16x32_bf16 v[56:59], v[80:83], v[108:111], v[56:59]
    v_mfma_f32_16x16x32_bf16 v[56:59], v[76:79], v[112:115], v[56:59]
    v_mfma_f32_16x16x32_bf16 v[60:63], v[80:83], v[112:115], v[60:63]
    ds_read2_b32 v[80:81], v21 offset0:0 offset1:1
    ds_read2_b32 v[82:83], v21 offset0:2 offset1:3
    ds_read_b128 v[112:115], v24 offset:1536
    v_mfma_f32_16x16x32_bf16 v[44:47], v[76:79], v[136:139], v[44:47]
    v_mfma_f32_16x16x32_bf16 v[44:47], v[132:135], v[108:111], v[44:47]
    v_mfma_f32_16x16x32_bf16 v[48:51], v[76:79], v[144:147], v[48:51]
    v_mfma_f32_16x16x32_bf16 v[48:51], v[140:143], v[108:111], v[48:51]
    v_mfma_f32_16x16x32_bf16 v[52:55], v[76:79], v[108:111], v[52:55]
    ds_read2_b32 v[76:77], v21 offset0:128 offset1:129
    ds_read2_b32 v[78:79], v21 offset0:130 offset1:131
    ds_read_b128 v[108:111], v24 offset:1024
    v_mfma_f32_16x16x32_bf16 v[40:43], v[140:143], v[136:139], v[40:43]
    v_mfma_f32_16x16x32_bf16 v[40:43], v[132:135], v[144:147], v[40:43]
    v_mfma_f32_16x16x32_bf16 v[44:47], v[140:143], v[144:147], v[44:47]
    v_mfma_f32_16x16x32_bf16 v[36:39], v[132:135], v[136:139], v[36:39]
    s_sub_u32 s83, s83, 1
    s_cmp_lg_u32 s83, 0
    s_cbranch_scc1 L_cv
    s_setprio 1
    s_waitcnt lgkmcnt(0)
    s_setprio 0
    s_mov_b32 s82, 400000
L_w_96:
    ds_read_b32 v4, v2 offset:208
    s_waitcnt lgkmcnt(0)
    v_readfirstlane_b32 s15, v4
    s_cmp_ge_u32 s15, 1
    s_cbranch_scc1 L_wd_97
    s_sleep 1
    s_sub_u32 s82, s82, 1
    s_cmp_lg_u32 s82, 0
    s_cbranch_scc1 L_w_96
L_wd_97:
    s_setprio 1
    s_sub_u32 s46, s15, 1
    ds_read_b64 v[68:69], v25 offset:0
    ds_read_b64 v[70:71], v25 offset:512
    ds_read_b64 v[72:73], v25 offset:1024
    ds_read_b64 v[74:75], v25 offset:1536
    ds_read_b64 v[76:77], v25 offset:2048
    ds_read_b64 v[78:79], v25 offset:2560
    ds_read_b64 v[80:81], v25 offset:3072
    ds_read_b64 v[82:83], v25 offset:3584
    s_mov_b64 exec, 1
    ds_add_u32 v2, v3 offset:152
    s_mov_b64 exec, -1
    s_waitcnt lgkmcnt(8)
    v_lshlrev_b32 v12, 16, v68
    v_and_b32 v13, 0xffff0000, v68
    v_lshlrev_b32 v14, 16, v69
    v_and_b32 v15, 0xffff0000, v69
    v_fmac_f32 v36, v12, v16
    v_fmac_f32 v37, v13, v16
    v_fmac_f32 v38, v14, v16
    v_fmac_f32 v39, v15, v16
    v_cvt_pk_bf16_f32 v100, v36, v37
    v_cvt_pk_bf16_f32 v101, v38, v39
    s_waitcnt lgkmcnt(7)
    v_lshlrev_b32 v12, 16, v70
    v_and_b32 v13, 0xffff0000, v70
    v_lshlrev_b32 v14, 16, v71
    v_and_b32 v15, 0xffff0000, v71
    v_fmac_f32 v40, v12, v16
    v_fmac_f32 v41, v13, v16
    v_fmac_f32 v42, v14, v16
    v_fmac_f32 v43, v15, v16
    v_cvt_pk_bf16_f32 v102, v40, v41
    v_cvt_pk_bf16_f32 v103, v42, v43
    s_nop 1
    v_permlane16_swap_b32 v100, v102
    v_permlane16_swap_b32 v101, v103
    s_cmp_eq_u32 s46, 0
    s_cbranch_scc1 L_tg_98
    buffer_store_dwordx4 v[100:103], v26, s[48:51], s90 offen
    s_branch L_td_99
L_tg_98:
    buffer_store_dwordx4 v[100:103], v26, s[48:51], s90 offen sc1
L_td_99:
    s_add_u32 s90, s90, 655360
    s_waitcnt lgkmcnt(6)
    v_lshlrev_b32 v12, 16, v72
    v_and_b32 v13, 0xffff0000, v72
    v_lshlrev_b32 v14, 16, v73
    v_and_b32 v15, 0xffff0000, v73
    v_fmac_f32 v44, v12, v16
    v_fmac_f32 v45, v13, v16
    v_fmac_f32 v46, v14, v16
    v_fmac_f32 v47, v15, v16
    v_cvt_pk_bf16_f32 v104, v44, v45
    v_cvt_pk_bf16_f32 v105, v46, v47
    s_waitcnt lgkmcnt(5)
    v_lshlrev_b32 v12, 16, v74
    v_and_b32 v13, 0xffff0000, v74
    v_lshlrev_b32 v14, 16, v75
    v_and_b32 v15, 0xffff0000, v75
    v_fmac_f32 v48, v12, v16
    v_fmac_f32 v49, v13, v16
    v_fmac_f32 v50, v14, v16
    v_fmac_f32 v51, v15, v16
    v_cvt_pk_bf16_f32 v106, v48, v49
    v_cvt_pk_bf16_f32 v107, v50, v51
    s_nop 1
    v_permlane16_swap_b32 v104, v106
    v_permlane16_swap_b32 v105, v107
    s_cmp_eq_u32 s46, 0
    s_cbranch_scc1 L_tg_100
    buffer_store_dwordx4 v[104:107], v26, s[48:51], s90 offen
    s_branch L_td_101
L_tg_100:
    buffer_store_dwordx4 v[104:107], v26, s[48:51], s90 offen sc1
L_td_101:
    s_add_u32 s90, s90, 655360
    s_waitcnt lgkmcnt(4)
    v_lshlrev_b32 v12, 16, v76
    v_and_b32 v13, 0xffff0000, v76
    v_lshlrev_b32 v14, 16, v77
    v_and_b32 v15, 0xffff0000, v77
    v_fmac_f32 v52, v12, v16
    v_fmac_f32 v53, v13, v16
    v_fmac_f32 v54, v14, v16
    v_fmac_f32 v55, v15, v16
    v_cvt_pk_bf16_f32 v108, v52, v53
    v_cvt_pk_bf16_f32 v109, v54, v55
    s_waitcnt lgkmcnt(3)
    v_lshlrev_b32 v12, 16, v78
    v_and_b32 v13, 0xffff0000, v78
    v_lshlrev_b32 v14, 16, v79
    v_and_b32 v15, 0xffff0000, v79
    v_fmac_f32 v56, v12, v16
    v_fmac_f32 v57, v13, v16
    v_fmac_f32 v58, v14, v16
    v_fmac_f32 v59, v15, v16
    v_cvt_pk_bf16_f32 v110, v56, v57
    v_cvt_pk_bf16_f32 v111, v58, v59
    s_nop 1
    v_permlane16_swap_b32 v108, v110
    v_permlane16_swap_b32 v109, v111
    s_cmp_eq_u32 s46, 0
    s_cbranch_scc1 L_tg_102
    buffer_store_dwordx4 v[108:111], v26, s[48:51], s90 offen
    s_branch L_td_103
L_tg_102:
    buffer_store_dwordx4 v[108:111], v26, s[48:51], s90 offen sc1
L_td_103:
    s_add_u32 s90, s90, 655360
    s_waitcnt lgkmcnt(2)
    v_lshlrev_b32 v12, 16, v80
    v_and_b32 v13, 0xffff0000, v80
    v_lshlrev_b32 v14, 16, v81
    v_and_b32 v15, 0xffff0000, v81
    v_fmac_f32 v60, v12, v16
    v_fmac_f32 v61, v13, v16
    v_fmac_f32 v62, v14, v16
    v_fmac_f32 v63, v15, v16
    v_cvt_pk_bf16_f32 v112, v60, v61
    v_cvt_pk_bf16_f32 v113, v62, v63
    s_waitcnt lgkmcnt(1)
    v_lshlrev_b32 v12, 16, v82
    v_and_b32 v13, 0xffff0000, v82
    v_lshlrev_b32 v14, 16, v83
    v_and_b32 v15, 0xffff0000, v83
    v_fmac_f32 v64, v12, v16
    v_fmac_f32 v65, v13, v16
    v_fmac_f32 v66, v14, v16
    v_fmac_f32 v67, v15, v16
    v_cvt_pk_bf16_f32 v114, v64, v65
    v_cvt_pk_bf16_f32 v115, v66, v67
    s_nop 1
    v_permlane16_swap_b32 v112, v114
    v_permlane16_swap_b32 v113, v115
    s_cmp_eq_u32 s46, 0
    s_cbranch_scc1 L_tg_104
    buffer_store_dwordx4 v[112:115], v26, s[48:51], s90 offen
    s_branch L_td_105
L_tg_104:
    buffer_store_dwordx4 v[112:115], v26, s[48:51], s90 offen sc1
L_td_105:
    s_add_u32 s90, s90, 655360
    s_lshl_b32 s8, s80, 7
    s_add_u32 s8, s8, 917504
    s_mul_i32 s9, s6, 80
    s_sub_u32 s9, s80, s9
    s_lshl_b32 s9, s9, 2
    s_lshl_b32 s10, s6, 9
    s_add_u32 s9, s9, s10
    s_add_u32 s9, s9, 471040
    s_cmp_eq_u32 s46, 0
    s_cselect_b32 s8, s8, s9
    v_mov_b32 v8, s7
    s_waitcnt vmcnt(0)
    s_cmp_eq_u32 s46, 0
    s_cbranch_scc1 L_tg_106
    s_mov_b64 exec, 1
    buffer_store_dword v8, off, s[48:51], s8
    s_mov_b64 exec, -1
    s_branch L_td_107
L_tg_106:
    s_mov_b64 exec, 1
    buffer_store_dword v8, off, s[48:51], s8 sc1
    s_mov_b64 exec, -1
L_td_107:
L_cv_done:
L_yout:
    s_mov_b32 s56, s40
    s_mov_b32 s57, s41
    s_mov_b32 s58, 5242880
    s_mov_b32 s59, 0x20000
    s_setprio 0
    ds_read_b32 v8, v2 offset:36
    s_lshr_b32 s92, s2, 3
    s_mul_i32 s88, s81, 2560
    s_add_u32 s88, s88, 66560
    s_mul_i32 s8, s92, 81920
    s_mul_i32 s10, s6, 10240
    s_add_u32 s8, s8, s10
    s_lshl_b32 s10, s81, 5
    s_add_u32 s8, s8, s10
    s_add_u32 s89, s8, 4194304
    v_lshrrev_b32 v5, 1, v1
    v_lshlrev_b32 v5, 7, v5
    v_and_b32 v4, 1, v1
    v_lshl_add_u32 v16, v4, 4, v5
    v_lshrrev_b32 v4, 4, v1
    v_bfe_u32 v5, v1, 2, 2
    v_and_b32 v6, 3, v1
    v_lshlrev_b32 v6, 3, v6
    v_lshl_add_u32 v6, v5, 5, v6
    v_add_u32 v6, s88, v6
    v_lshl_add_u32 v20, v4, 8, v6
    v_and_b32 v7, 1, v4
    v_lshl_add_u32 v21, v7, 8, v6
    v_and_b32 v5, 15, v1
    v_mul_u32_u24 v5, 2560, v5
    v_lshl_add_u32 v22, v4, 4, v5
    s_lshl_b32 s8, s92, 6
    s_lshl_b32 s10, s81, 4
    s_add_u32 s8, s8, s10
    s_mul_i32 s8, s8, 2560
    s_mul_i32 s10, s6, 160
    s_add_u32 s8, s8, s10
    s_add_u32 s90, s8, 1280
    s_waitcnt lgkmcnt(0)
    v_readfirstlane_b32 s7, v8
    s_mov_b32 s82, 400000
L_w_108:
    ds_read_b32 v4, v2 offset:208
    s_waitcnt lgkmcnt(0)
    v_readfirstlane_b32 s15, v4
    s_cmp_ge_u32 s15, 1
    s_cbranch_scc1 L_wd_109
    s_sleep 1
    s_sub_u32 s82, s82, 1
    s_cmp_lg_u32 s82, 0
    s_cbranch_scc1 L_w_108
L_wd_109:
    s_sub_u32 s46, s15, 1
    s_mov_b32 s82, 400000
L_w_110:
    ds_read_b32 v4, v2 offset:228
    s_waitcnt lgkmcnt(0)
    v_readfirstlane_b32 s15, v4
    s_cmp_ge_u32 s15, 8
    s_cbranch_scc1 L_wd_111
    s_sleep 1
    s_sub_u32 s82, s82, 1
    s_cmp_lg_u32 s82, 0
    s_cbranch_scc1 L_w_110
L_wd_111:
    s_cmp_eq_u32 s46, 0
    s_cselect_b32 s14, 7, 2
    s_mul_i32 s9, s6, 10240
    s_add_u32 s9, s9, 917504
    s_lshl_b32 s10, s6, 9
    s_add_u32 s10, s10, 471040
    s_cmp_eq_u32 s46, 0
    s_cselect_b32 s9, s9, s10
    v_lshlrev_b32 v10, s14, v1
    v_and_b32 v12, 15, v1
    v_add_u32 v12, 64, v12
    v_lshlrev_b32 v12, s14, v12
    s_mov_b32 s82, 400000
L_py:
    buffer_load_dword v11, v10, s[48:51], s9 offen sc1
    buffer_load_dword v13, v12, s[48:51], s9 offen sc1
    s_waitcnt vmcnt(0)
    v_xor_b32 v11, s7, v11
    v_xor_b32 v13, s7, v13
    v_or_b32 v11, v11, v13
    v_cmp_ne_u32 vcc, 0, v11
    s_cbranch_vccz L_py_go
    s_sleep 1
    s_sub_u32 s82, s82, 1
    s_cmp_lg_u32 s82, 0
    s_cbranch_scc1 L_py
L_py_go:
    s_add_u32 m0, s88, 0
    s_nop 0
    buffer_load_dwordx4 v16, s[48:51], s89 offen sc1 lds
    s_add_u32 s89, s89, 4096
    s_add_u32 m0, s88, 1024
    s_nop 0
    buffer_load_dwordx4 v16, s[48:51], s89 offen sc1 lds
    s_add_u32 s89, s89, 4096
    s_mov_b32 exec_hi, 0
    s_add_u32 m0, s88, 2048
    s_nop 0
    buffer_load_dwordx4 v16, s[48:51], s89 offen sc1 lds
    s_add_u32 s89, s89, 4096
    s_mov_b64 exec, -1
    s_waitcnt vmcnt(0)
    ds_read_b64_tr_b16 v[24:25], v20 offset:0
    ds_read_b64_tr_b16 v[26:27], v20 offset:128
    ds_read_b64_tr_b16 v[28:29], v20 offset:1024
    ds_read_b64_tr_b16 v[30:31], v20 offset:1152
    ds_read_b64_tr_b16 v[32:33], v21 offset:2048
    ds_read_b64_tr_b16 v[34:35], v21 offset:2176
    s_waitcnt lgkmcnt(0)
    buffer_store_dwordx4 v[24:27], v22, s[56:59], s90 offen
    buffer_store_dwordx4 v[28:31], v22, s[56:59], s90 offen offset:64
    s_mov_b32 exec_hi, 0
    buffer_store_dwordx4 v[32:35], v22, s[56:59], s90 offen offset:128
    s_mov_b64 exec, -1
L_exit:
    s_endpgm
L_cend:
.section .rodata,"a"
.p2align 6
.amdhsa_kernel concat_heads__grouped_kv_mqa__ssm_conv_s4d__prompt_kernel
  .amdhsa_next_free_vgpr 168
  .amdhsa_next_free_sgpr 96
  .amdhsa_accum_offset 168
  .amdhsa_group_segment_fixed_size 0
  .amdhsa_kernarg_size 120
  .amdhsa_user_sgpr_count 2
  .amdhsa_user_sgpr_kernarg_segment_ptr 1
  .amdhsa_system_sgpr_workgroup_id_x 1
  .amdhsa_float_denorm_mode_32 3
.end_amdhsa_kernel
```
